```python
import torch

def _softmax(x, axis=-1):
    return torch.softmax(x, dim=axis)
def _gelu(x):
    return torch.nn.functional.gelu(x, approximate="tanh")
def _silu(x):
    return torch.nn.functional.silu(x)
def _sigmoid(x):
    return torch.sigmoid(x)
def _layernorm(x, axis=-1, eps=1e-5):
    m = x.mean(dim=axis, keepdim=True)
    v = x.var(dim=axis, keepdim=True, unbiased=False)
    return (x - m) / torch.sqrt(v + eps)
def _scatter_add(tgt, idx, src, axis=0):
    return tgt.clone().index_add_(axis, idx, src)
def _segment_sum(src, seg, n):
    out = torch.zeros((n,) + src.shape[1:], dtype=src.dtype)
    return out.index_add_(0, seg, src)
def _pad(x, pw):
    flat = tuple(v for pair in reversed(pw) for v in pair)
    return torch.nn.functional.pad(x, flat)

kernel_name = 'recurrent_scan__linear_attn_block__swiglu_ffn__prompt'

def setup_inputs():

    _w = (lambda a: (lambda t: t.to(torch.bfloat16) if t.is_floating_point() else t)(torch.as_tensor(a)))
    def _A_setup():
        B, S, D = 1, 2048, 448
        return {
            "x": _w((lambda *s: torch.randn(*s, dtype=torch.bfloat16) * 0.05)(B, S, D)),
            "wqkv": _w((lambda *s: torch.randn(*s, dtype=torch.bfloat16) * 0.05)(D, 3 * D)),
            "wo": _w((lambda *s: torch.randn(*s, dtype=torch.bfloat16) * 0.05)(D, D)),
        }
    _A_in = _A_setup()

    def _B_setup():
        B, S, D, F = 1, 2048, 448, 1792
        return {
            "x": _w((lambda *s: torch.randn(*s, dtype=torch.bfloat16) * 0.05)(B, S, D)),
            "w_gate": _w((lambda *s: torch.randn(*s, dtype=torch.bfloat16) * 0.05)(D, F)),
            "w_up": _w((lambda *s: torch.randn(*s, dtype=torch.bfloat16) * 0.05)(D, F)),
            "w_down": _w((lambda *s: torch.randn(*s, dtype=torch.bfloat16) * 0.05)(F, D)),
        }
    _B_in = _B_setup()

    return {
        "A_x": _A_in["x"],
        "A_wqkv": _A_in["wqkv"],
        "A_wo": _A_in["wo"],
        "B_x": _B_in["x"],
        "B_w_gate": _B_in["w_gate"],
        "B_w_up": _B_in["w_up"],
        "B_w_down": _B_in["w_down"],
    }

def reference(A_x, A_wqkv, A_wo, B_x, B_w_gate, B_w_up, B_w_down):
    def _A_ref(x, wqkv, wo):
        B, S, D = x.shape
        H = 16; Dh = D // H
        qkv = (lambda x, *d: x.permute(*d))((x @ wqkv).reshape(B, S, 3, H, Dh), 2, 0, 3, 1, 4)
        q, k, v = qkv[0], qkv[1], qkv[2]
        phi = lambda t: torch.where(t > 0, t + 1, torch.exp(t)) + 1e-6
        pq, pk = phi(q), phi(k)
        kv = torch.einsum("bhsd,bhse->bhde", pk, v)
        z = torch.einsum("bhsd->bhd", pk)
        num = torch.einsum("bhqd,bhde->bhqe", pq, kv)
        den = torch.einsum("bhqd,bhd->bhq", pq, z)[..., None] + 1e-6
        o = num / den
        return (lambda x, *d: x.permute(*d))(o, 0, 2, 1, 3).reshape(B, S, D) @ wo

    def _B_ref(x, w_gate, w_up, w_down):
        g = _silu(x @ w_gate)
        u = x @ w_up
        return (g * u) @ w_down

    x = A_x
    xn = _layernorm(x, axis=-1)
    s = _A_ref(xn, A_wqkv, A_wo)
    g = _silu(_B_ref(xn, B_w_gate, B_w_up, B_w_down))
    return x + s * g
```

```asm
; @launch grid=(256,1,1) block=(512,1,1) lds=163840
.amdgcn_target "amdgcn-amd-amdhsa--gfx950"
.text
.globl recurrent_scan__linear_attn_block__swiglu_ffn__prompt_kernel
.p2align 8
.type recurrent_scan__linear_attn_block__swiglu_ffn__prompt_kernel,@function
recurrent_scan__linear_attn_block__swiglu_ffn__prompt_kernel:
    s_cmp_ge_u32 s2, 256
    s_cbranch_scc1 L_done
    s_cmp_ge_u32 s2, 16
    s_cbranch_scc1 L_nopf
    s_getpc_b64 s[4:5]
    s_lshr_b32 s6, s2, 3
    s_lshl_b32 s6, s6, 15
    v_lshlrev_b32 v222, 6, v0
    v_add_u32 v222, s6, v222
    v_min_u32 v222, 0xa000, v222
    global_load_dword v223, v222, s[4:5]
L_nopf:
    s_load_dwordx4 s[4:7], s[0:1], 0
    s_load_dwordx4 s[20:23], s[0:1], 64
    s_load_dwordx4 s[12:15], s[0:1], 32
    s_load_dwordx4 s[16:19], s[0:1], 48
    s_load_dwordx2 s[8:9], s[0:1], 16
    v_lshrrev_b32 v1, 6, v0
    v_and_b32 v0, 63, v0
    v_readfirstlane_b32 s3, v1
    v_lshrrev_b32 v32, 3, v0
    v_and_b32 v33, 7, v0
    v_xor_b32 v33, v33, v32
    v_lshlrev_b32 v33, 4, v33
    v_mul_u32_u24 v34, 896, v32
    v_add_u32 v2, v34, v33
    v_add_u32 v3, 6144, v2
    v_xor_b32 v33, 16, v33
    v_add_u32 v4, v34, v33
    v_add_u32 v4, 12288, v4
    v_add_u32 v5, 6144, v4
    s_and_b32 s52, s3, 3
    s_and_b32 s53, s2, 3
    s_lshl_b32 s53, s53, 2
    s_lshr_b32 s69, s2, 3
    s_and_b32 s64, s69, 3
    s_add_u32 s53, s53, s64
    s_lshl_b32 s57, s53, 2
    s_add_u32 s57, s57, s52
    s_mul_i32 s58, s57, 28672
    s_mul_i32 s66, s52, 28672
    s_add_u32 s66, s66, 49152
    s_lshl_b32 s70, s64, 1
    s_lshr_b32 s55, s69, 2
    s_add_u32 s70, s70, s55
    s_cmp_ge_u32 s70, 7
    s_cselect_b32 s71, 7, 0
    s_sub_u32 s70, s70, s71
    s_cmp_ge_u32 s70, 7
    s_cselect_b32 s71, 7, 0
    s_sub_u32 s70, s70, s71
    s_mov_b32 s71, s70
    s_bfe_u32 s54, s2, 0x10002
    s_lshl_b32 s56, s54, 3
    s_add_u32 s56, s56, s55
    s_cmp_ge_u32 s56, 14
    s_cselect_b32 s65, 1, 0
    s_xor_b32 s56, s56, s65
    s_lshl_b32 s63, s52, 10
    s_lshl_b32 s68, s2, 3
    s_add_u32 s68, s68, s3
    v_mov_b32 v31, 0xa20000
    v_mov_b32 v30, 0
    s_waitcnt lgkmcnt(0)
    s_mov_b32 s24, s4
    s_mov_b32 s25, s5
    s_mov_b32 s26, 0x1c0000
    s_mov_b32 s27, 0x20000
    s_cmp_ge_u32 s3, 4
    s_cbranch_scc1 L_H
    s_cmp_lg_u32 s68, 0
    s_cbranch_scc1 L_notag1
    global_load_dword v30, v31, s[22:23] sc1
L_notag1:
    s_add_u32 m0, s66, 0
    s_lshl_b32 s68, s71, 7
    s_add_u32 s68, s68, s58
    s_add_u32 s71, s71, 1
    s_cmp_eq_u32 s71, 7
    s_cselect_b32 s71, 0, s71
    buffer_load_dwordx4 v2, s[24:27], s68 offen offset:0 lds
    buffer_load_dwordx4 v3, s[24:27], s68 offen offset:1024 lds
    buffer_load_dwordx4 v4, s[24:27], s68 offen offset:2048 lds
    buffer_load_dwordx4 v5, s[24:27], s68 offen offset:3072 lds
    s_add_u32 m0, s66, 4096
    s_lshl_b32 s68, s71, 7
    s_add_u32 s68, s68, s58
    s_add_u32 s71, s71, 1
    s_cmp_eq_u32 s71, 7
    s_cselect_b32 s71, 0, s71
    buffer_load_dwordx4 v2, s[24:27], s68 offen offset:0 lds
    buffer_load_dwordx4 v3, s[24:27], s68 offen offset:1024 lds
    buffer_load_dwordx4 v4, s[24:27], s68 offen offset:2048 lds
    buffer_load_dwordx4 v5, s[24:27], s68 offen offset:3072 lds
    s_add_u32 m0, s66, 8192
    s_lshl_b32 s68, s71, 7
    s_add_u32 s68, s68, s58
    s_add_u32 s71, s71, 1
    s_cmp_eq_u32 s71, 7
    s_cselect_b32 s71, 0, s71
    buffer_load_dwordx4 v2, s[24:27], s68 offen offset:0 lds
    buffer_load_dwordx4 v3, s[24:27], s68 offen offset:1024 lds
    buffer_load_dwordx4 v4, s[24:27], s68 offen offset:2048 lds
    buffer_load_dwordx4 v5, s[24:27], s68 offen offset:3072 lds
    s_mov_b32 s28, s6
    s_mov_b32 s29, s7
    s_mov_b32 s30, 0x126000
    s_mov_b32 s31, 0x20000
    v_lshrrev_b32 v32, 3, v0
    v_mul_u32_u24 v10, 2688, v32
    v_lshrrev_b32 v33, 1, v32
    v_lshrrev_b32 v34, 2, v0
    v_xor_b32 v33, v33, v34
    v_and_b32 v33, 1, v33
    v_mul_u32_u24 v33, 896, v33
    v_and_b32 v34, 3, v0
    v_lshlrev_b32 v34, 4, v34
    v_add3_u32 v10, v10, v33, v34
    v_add_u32 v10, 896, v10
    s_mul_i32 s59, s56, 56
    s_mul_i32 s64, s52, 21504
    s_add_u32 s59, s59, s64
    s_add_u32 s11, s59, 0x126000
    s_mul_i32 s64, s70, 172032
    s_add_u32 s59, s59, s64
    s_sub_u32 s59, s59, 0x15000
    s_mov_b32 s36, s22
    s_mov_b32 s37, s23
    s_mov_b32 s38, 0xc00000
    s_mov_b32 s39, 0x20000
    v_and_b32 v32, 31, v0
    v_lshrrev_b32 v33, 5, v0
    v_and_b32 v34, 7, v32
    v_lshrrev_b32 v35, 4, v32
    v_xor_b32 v35, v35, v34
    v_xor_b32 v35, v35, v33
    v_lshlrev_b32 v35, 4, v35
    v_lshl_add_u32 v35, v34, 7, v35
    v_lshrrev_b32 v34, 3, v32
    v_lshl_add_u32 v35, v34, 10, v35
    v_add_u32 v6, s66, v35
    v_xor_b32 v7, 32, v6
    v_xor_b32 v8, 64, v6
    v_xor_b32 v9, 96, v6
    v_and_b32 v32, 31, v0
    v_lshrrev_b32 v33, 5, v0
    v_lshlrev_b32 v33, 3, v33
    v_sub_u32 v32, v32, v33
    v_and_b32 v33, 1, v32
    v_lshlrev_b32 v33, 4, v33
    v_mov_b32 v34, 0x3f80
    v_lshlrev_b32 v34, v33, v34
    v_ashrrev_i32 v32, 1, v32
    v_cmp_eq_u32 vcc, 0, v32
    s_nop 1
    v_cndmask_b32 v12, 0, v34, vcc
    v_cmp_eq_u32 vcc, 8, v32
    s_nop 1
    v_cndmask_b32 v16, 0, v34, vcc
    v_cmp_eq_u32 vcc, 1, v32
    s_nop 1
    v_cndmask_b32 v13, 0, v34, vcc
    v_cmp_eq_u32 vcc, 9, v32
    s_nop 1
    v_cndmask_b32 v17, 0, v34, vcc
    v_cmp_eq_u32 vcc, 2, v32
    s_nop 1
    v_cndmask_b32 v14, 0, v34, vcc
    v_cmp_eq_u32 vcc, 10, v32
    s_nop 1
    v_cndmask_b32 v18, 0, v34, vcc
    v_cmp_eq_u32 vcc, 3, v32
    s_nop 1
    v_cndmask_b32 v15, 0, v34, vcc
    v_cmp_eq_u32 vcc, 11, v32
    s_nop 1
    v_cndmask_b32 v19, 0, v34, vcc
    v_bfe_u32 v39, v0, 2, 2
    v_bfe_u32 v37, v0, 4, 1
    v_lshrrev_b32 v36, 5, v0
    v_lshl_add_u32 v36, v36, 2, v39
    v_and_b32 v38, 3, v0
    v_lshlrev_b32 v38, 3, v38
    v_lshlrev_b32 v32, 7, v36
    v_lshl_add_u32 v32, v37, 5, v32
    v_add_u32 v32, v32, v38
    v_lshrrev_b32 v33, 1, v39
    v_lshl_add_u32 v10, v33, 6, v32
    v_xor_b32 v11, 64, v10
    v_lshlrev_b32 v1, 4, v0
    v_and_b32 v32, 31, v0
    v_cmp_eq_u32 vcc, 28, v32
    v_mov_b32 v33, 0x3f803f80
    s_nop 0
    v_cndmask_b32 v29, 0, v33, vcc
    v_mov_b32 v24, 0
    v_mov_b32 v25, 0
    v_mov_b32 v26, 0
    v_mov_b32 v27, 0
    v_mov_b32 v28, 0x3f803f80
    s_waitcnt vmcnt(8)
    ds_read_b128 v[112:115], v6 offset:0
    ds_read_b128 v[116:119], v7 offset:0
    ds_read_b128 v[120:123], v8 offset:0
    ds_read_b128 v[124:127], v9 offset:0
    s_waitcnt vmcnt(4) lgkmcnt(0)
    ds_read_b128 v[128:131], v6 offset:4096
    ds_read_b128 v[132:135], v7 offset:4096
    ds_read_b128 v[136:139], v8 offset:4096
    ds_read_b128 v[140:143], v9 offset:4096
    v_dot2c_f32_bf16 v24, v112, v28
    v_dot2c_f32_bf16 v26, v112, v112
    v_dot2c_f32_bf16 v25, v113, v28
    v_dot2c_f32_bf16 v27, v113, v113
    v_dot2c_f32_bf16 v24, v114, v28
    v_dot2c_f32_bf16 v26, v114, v114
    v_dot2c_f32_bf16 v25, v115, v28
    v_dot2c_f32_bf16 v27, v115, v115
    v_dot2c_f32_bf16 v24, v116, v28
    v_dot2c_f32_bf16 v26, v116, v116
    v_dot2c_f32_bf16 v25, v117, v28
    v_dot2c_f32_bf16 v27, v117, v117
    v_dot2c_f32_bf16 v24, v118, v28
    v_dot2c_f32_bf16 v26, v118, v118
    v_dot2c_f32_bf16 v25, v119, v28
    v_dot2c_f32_bf16 v27, v119, v119
    v_dot2c_f32_bf16 v24, v120, v28
    v_dot2c_f32_bf16 v26, v120, v120
    v_dot2c_f32_bf16 v25, v121, v28
    v_dot2c_f32_bf16 v27, v121, v121
    v_dot2c_f32_bf16 v24, v122, v28
    v_dot2c_f32_bf16 v26, v122, v122
    v_dot2c_f32_bf16 v25, v123, v28
    v_dot2c_f32_bf16 v27, v123, v123
    v_dot2c_f32_bf16 v24, v124, v28
    v_dot2c_f32_bf16 v26, v124, v124
    v_dot2c_f32_bf16 v25, v125, v28
    v_dot2c_f32_bf16 v27, v125, v125
    v_dot2c_f32_bf16 v24, v126, v28
    v_dot2c_f32_bf16 v26, v126, v126
    v_dot2c_f32_bf16 v25, v127, v28
    v_dot2c_f32_bf16 v27, v127, v127
    s_waitcnt vmcnt(0) lgkmcnt(0)
    ds_read_b128 v[144:147], v6 offset:8192
    ds_read_b128 v[148:151], v7 offset:8192
    ds_read_b128 v[152:155], v8 offset:8192
    ds_read_b128 v[156:159], v9 offset:8192
    v_dot2c_f32_bf16 v24, v128, v28
    v_dot2c_f32_bf16 v26, v128, v128
    v_dot2c_f32_bf16 v25, v129, v28
    v_dot2c_f32_bf16 v27, v129, v129
    v_dot2c_f32_bf16 v24, v130, v28
    v_dot2c_f32_bf16 v26, v130, v130
    v_dot2c_f32_bf16 v25, v131, v28
    v_dot2c_f32_bf16 v27, v131, v131
    v_dot2c_f32_bf16 v24, v132, v28
    v_dot2c_f32_bf16 v26, v132, v132
    v_dot2c_f32_bf16 v25, v133, v28
    v_dot2c_f32_bf16 v27, v133, v133
    v_dot2c_f32_bf16 v24, v134, v28
    v_dot2c_f32_bf16 v26, v134, v134
    v_dot2c_f32_bf16 v25, v135, v28
    v_dot2c_f32_bf16 v27, v135, v135
    v_dot2c_f32_bf16 v24, v136, v28
    v_dot2c_f32_bf16 v26, v136, v136
    v_dot2c_f32_bf16 v25, v137, v28
    v_dot2c_f32_bf16 v27, v137, v137
    v_dot2c_f32_bf16 v24, v138, v28
    v_dot2c_f32_bf16 v26, v138, v138
    v_dot2c_f32_bf16 v25, v139, v28
    v_dot2c_f32_bf16 v27, v139, v139
    v_dot2c_f32_bf16 v24, v140, v28
    v_dot2c_f32_bf16 v26, v140, v140
    v_dot2c_f32_bf16 v25, v141, v28
    v_dot2c_f32_bf16 v27, v141, v141
    v_dot2c_f32_bf16 v24, v142, v28
    v_dot2c_f32_bf16 v26, v142, v142
    v_dot2c_f32_bf16 v25, v143, v28
    v_dot2c_f32_bf16 v27, v143, v143
    s_waitcnt lgkmcnt(0)
    v_dot2c_f32_bf16 v24, v144, v28
    v_dot2c_f32_bf16 v26, v144, v144
    v_dot2c_f32_bf16 v25, v145, v28
    v_dot2c_f32_bf16 v27, v145, v145
    v_dot2c_f32_bf16 v24, v146, v28
    v_dot2c_f32_bf16 v26, v146, v146
    v_dot2c_f32_bf16 v25, v147, v28
    v_dot2c_f32_bf16 v27, v147, v147
    v_dot2c_f32_bf16 v24, v148, v28
    v_dot2c_f32_bf16 v26, v148, v148
    v_dot2c_f32_bf16 v25, v149, v28
    v_dot2c_f32_bf16 v27, v149, v149
    v_dot2c_f32_bf16 v24, v150, v28
    v_dot2c_f32_bf16 v26, v150, v150
    v_dot2c_f32_bf16 v25, v151, v28
    v_dot2c_f32_bf16 v27, v151, v151
    v_dot2c_f32_bf16 v24, v152, v28
    v_dot2c_f32_bf16 v26, v152, v152
    v_dot2c_f32_bf16 v25, v153, v28
    v_dot2c_f32_bf16 v27, v153, v153
    v_dot2c_f32_bf16 v24, v154, v28
    v_dot2c_f32_bf16 v26, v154, v154
    v_dot2c_f32_bf16 v25, v155, v28
    v_dot2c_f32_bf16 v27, v155, v155
    v_dot2c_f32_bf16 v24, v156, v28
    v_dot2c_f32_bf16 v26, v156, v156
    v_dot2c_f32_bf16 v25, v157, v28
    v_dot2c_f32_bf16 v27, v157, v157
    v_dot2c_f32_bf16 v24, v158, v28
    v_dot2c_f32_bf16 v26, v158, v158
    v_dot2c_f32_bf16 v25, v159, v28
    v_dot2c_f32_bf16 v27, v159, v159
    s_nop 1
    v_add_f32 v24, v24, v25
    v_add_f32 v26, v26, v27
    s_lshl_b32 s64, s52, 9
    v_lshlrev_b32 v32, 2, v0
    v_add_u32 v32, s64, v32
    s_barrier
    ds_read_b32 v25, v32 offset:45056
    ds_read_b32 v27, v32 offset:45312
    ds_read_b128 v[160:163], v6 offset:12288
    ds_read_b128 v[164:167], v7 offset:12288
    ds_read_b128 v[168:171], v8 offset:12288
    ds_read_b128 v[172:175], v9 offset:12288
    ds_read_b128 v[176:179], v6 offset:16384
    ds_read_b128 v[180:183], v7 offset:16384
    ds_read_b128 v[184:187], v8 offset:16384
    ds_read_b128 v[188:191], v9 offset:16384
    ds_read_b128 v[192:195], v6 offset:20480
    ds_read_b128 v[196:199], v7 offset:20480
    ds_read_b128 v[200:203], v8 offset:20480
    ds_read_b128 v[204:207], v9 offset:20480
    ds_read_b128 v[208:211], v6 offset:24576
    s_waitcnt lgkmcnt(14)
    ds_read_b128 v[212:215], v7 offset:24576
    s_waitcnt lgkmcnt(14)
    ds_read_b128 v[216:219], v8 offset:24576
    s_waitcnt lgkmcnt(14)
    ds_read_b128 v[220:223], v9 offset:24576
    v_add_f32 v24, v24, v25
    v_add_f32 v26, v26, v27
    v_mov_b32 v25, v24
    v_mov_b32 v27, v26
    s_nop 0
    v_permlane32_swap_b32 v24, v25
    v_permlane32_swap_b32 v26, v27
    v_add_f32 v24, v24, v25
    v_add_f32 v26, v26, v27
    v_mul_f32 v24, 0xbb124925, v24
    v_mul_f32 v26, 0x3b124925, v26
    v_mov_b32 v32, v24
    v_mov_b32 v33, v24
    v_mov_b32 v34, v24
    v_mov_b32 v35, v24
    v_mov_b32 v36, v24
    v_mov_b32 v37, v24
    v_mov_b32 v38, v24
    v_mov_b32 v39, v24
    v_mov_b32 v40, v24
    v_mov_b32 v41, v24
    v_mov_b32 v42, v24
    v_mov_b32 v43, v24
    v_mov_b32 v44, v24
    v_mov_b32 v45, v24
    v_mov_b32 v46, v24
    v_mov_b32 v47, v24
    s_lshl_b32 s68, s2, 3
    s_add_u32 s68, s68, s52
    s_cmp_lg_u32 s68, 0
    s_cbranch_scc1 L_notag2
    s_mov_b32 s68, 0x9e3779b1
    v_mul_lo_u32 v30, v30, s68
    v_add_u32 v30, 0x7f4a7c15, v30
    v_or_b32 v30, 1, v30
    v_mov_b32 v2, 0
    global_store_dword v31, v30, s[22:23] sc1
    global_store_dword v2, v30, s[20:21] sc1
    s_nop 1
L_notag2:
    v_mfma_f32_32x32x16_bf16 v[48:63], v[12:15], v[112:115], v[32:47]
    v_fma_f32 v26, -v24, v24, v26
    v_max_f32 v26, 0, v26
    v_add_f32 v25, 0x3727c5ac, v26
    v_rsq_f32 v26, v25
    v_and_b32 v3, 31, v0
    v_mfma_f32_32x32x16_bf16 v[48:63], v[16:19], v[116:119], v[48:63]
    v_lshlrev_b32 v3, 2, v3
    v_mul_f32 v27, 0x3fb8aa3b, v26
    v_mul_f32 v24, 0xbfb8aa3b, v26
    s_lshl_b32 s64, s52, 8
    s_add_u32 s64, s64, 47104
    v_add_u32 v3, s64, v3
    s_waitcnt lgkmcnt(14)
    ds_write_b32 v3, v26
    s_waitcnt lgkmcnt(14)
    ds_write_b32 v3, v27 offset:128
    v_lshrrev_b32 v4, 5, v0
    v_lshlrev_b32 v4, 4, v4
    v_add_u32 v4, s64, v4
    v_cmp_gt_u32 vcc, 32, v0
    s_nop 1
    v_cndmask_b32 v28, 0, -1, vcc
    v_mfma_f32_32x32x16_bf16 v[64:79], v[12:15], v[120:123], v[32:47]
    v_cvt_pk_bf16_f32 v112, v48, v49
    v_cvt_pk_bf16_f32 v113, v50, v51
    v_cvt_pk_bf16_f32 v114, v52, v53
    v_cvt_pk_bf16_f32 v115, v54, v55
    v_cvt_pk_bf16_f32 v116, v56, v57
    v_cvt_pk_bf16_f32 v117, v58, v59
    v_cvt_pk_bf16_f32 v118, v60, v61
    v_cvt_pk_bf16_f32 v119, v62, v63
    v_mfma_f32_32x32x16_bf16 v[64:79], v[16:19], v[124:127], v[64:79]
    s_waitcnt lgkmcnt(2)
    s_barrier
    ds_read_b64_tr_b16 a[0:1], v10 offset:0
    ds_read_b64_tr_b16 a[2:3], v10 offset:1024
    ds_read_b64_tr_b16 a[4:5], v11 offset:0
    ds_read_b64_tr_b16 a[6:7], v11 offset:1024
    v_mfma_f32_32x32x16_bf16 v[48:63], v[12:15], v[128:131], v[32:47]
    s_nop 4
    v_cvt_pk_bf16_f32 v120, v64, v65
    v_cvt_pk_bf16_f32 v121, v66, v67
    v_cvt_pk_bf16_f32 v122, v68, v69
    v_cvt_pk_bf16_f32 v123, v70, v71
    v_cvt_pk_bf16_f32 v124, v72, v73
    v_cvt_pk_bf16_f32 v125, v74, v75
    v_mfma_f32_32x32x16_bf16 v[48:63], v[16:19], v[132:135], v[48:63]
    v_cvt_pk_bf16_f32 v126, v76, v77
    v_cvt_pk_bf16_f32 v127, v78, v79
    s_waitcnt lgkmcnt(2)
    v_mfma_f32_32x32x16_bf16 v[80:95], v[112:115], a[0:3], 0
    ds_read_b64_tr_b16 a[16:17], v10 offset:2048
    ds_read_b64_tr_b16 a[18:19], v10 offset:3072
    s_waitcnt lgkmcnt(2)
    v_mfma_f32_32x32x16_bf16 v[96:111], v[112:115], a[4:7], 0
    ds_read_b64_tr_b16 a[20:21], v11 offset:2048
    ds_read_b64_tr_b16 a[22:23], v11 offset:3072
    s_waitcnt lgkmcnt(2)
    v_mfma_f32_32x32x16_bf16 v[80:95], v[116:119], a[16:19], v[80:95]
    ds_read_b64_tr_b16 a[0:1], v10 offset:4096
    ds_read_b64_tr_b16 a[2:3], v10 offset:5120
    s_waitcnt lgkmcnt(2)
    v_mfma_f32_32x32x16_bf16 v[96:111], v[116:119], a[20:23], v[96:111]
    ds_read_b64_tr_b16 a[4:5], v11 offset:4096
    ds_read_b64_tr_b16 a[6:7], v11 offset:5120
    v_mfma_f32_32x32x16_bf16 v[64:79], v[12:15], v[136:139], v[32:47]
    v_cvt_pk_bf16_f32 v128, v48, v49
    v_cvt_pk_bf16_f32 v129, v50, v51
    v_cvt_pk_bf16_f32 v130, v52, v53
    v_cvt_pk_bf16_f32 v131, v54, v55
    v_cvt_pk_bf16_f32 v132, v56, v57
    v_cvt_pk_bf16_f32 v133, v58, v59
    v_mfma_f32_32x32x16_bf16 v[64:79], v[16:19], v[140:143], v[64:79]
    v_cvt_pk_bf16_f32 v134, v60, v61
    v_cvt_pk_bf16_f32 v135, v62, v63
    s_waitcnt lgkmcnt(2)
    v_mfma_f32_32x32x16_bf16 v[80:95], v[120:123], a[0:3], v[80:95]
    ds_read_b64_tr_b16 a[16:17], v10 offset:6144
    ds_read_b64_tr_b16 a[18:19], v10 offset:7168
    s_waitcnt lgkmcnt(2)
    v_mfma_f32_32x32x16_bf16 v[96:111], v[120:123], a[4:7], v[96:111]
    ds_read_b64_tr_b16 a[20:21], v11 offset:6144
    ds_read_b64_tr_b16 a[22:23], v11 offset:7168
    s_waitcnt lgkmcnt(2)
    v_mfma_f32_32x32x16_bf16 v[80:95], v[124:127], a[16:19], v[80:95]
    ds_read_b64_tr_b16 a[0:1], v10 offset:8192
    ds_read_b64_tr_b16 a[2:3], v10 offset:9216
    s_waitcnt lgkmcnt(2)
    v_mfma_f32_32x32x16_bf16 v[96:111], v[124:127], a[20:23], v[96:111]
    ds_read_b64_tr_b16 a[4:5], v11 offset:8192
    ds_read_b64_tr_b16 a[6:7], v11 offset:9216
    v_mfma_f32_32x32x16_bf16 v[48:63], v[12:15], v[144:147], v[32:47]
    v_cvt_pk_bf16_f32 v136, v64, v65
    v_cvt_pk_bf16_f32 v137, v66, v67
    v_cvt_pk_bf16_f32 v138, v68, v69
    v_cvt_pk_bf16_f32 v139, v70, v71
    v_cvt_pk_bf16_f32 v140, v72, v73
    v_cvt_pk_bf16_f32 v141, v74, v75
    v_mfma_f32_32x32x16_bf16 v[48:63], v[16:19], v[148:151], v[48:63]
    v_cvt_pk_bf16_f32 v142, v76, v77
    v_cvt_pk_bf16_f32 v143, v78, v79
    s_waitcnt lgkmcnt(2)
    v_mfma_f32_32x32x16_bf16 v[80:95], v[128:131], a[0:3], v[80:95]
    ds_read_b64_tr_b16 a[16:17], v10 offset:10240
    ds_read_b64_tr_b16 a[18:19], v10 offset:11264
    s_waitcnt lgkmcnt(2)
    v_mfma_f32_32x32x16_bf16 v[96:111], v[128:131], a[4:7], v[96:111]
    ds_read_b64_tr_b16 a[20:21], v11 offset:10240
    ds_read_b64_tr_b16 a[22:23], v11 offset:11264
    s_waitcnt lgkmcnt(2)
    v_mfma_f32_32x32x16_bf16 v[80:95], v[132:135], a[16:19], v[80:95]
    ds_read_b64_tr_b16 a[0:1], v10 offset:12288
    ds_read_b64_tr_b16 a[2:3], v10 offset:13312
    s_waitcnt lgkmcnt(2)
    v_mfma_f32_32x32x16_bf16 v[96:111], v[132:135], a[20:23], v[96:111]
    ds_read_b64_tr_b16 a[4:5], v11 offset:12288
    ds_read_b64_tr_b16 a[6:7], v11 offset:13312
    v_mfma_f32_32x32x16_bf16 v[64:79], v[12:15], v[152:155], v[32:47]
    v_cvt_pk_bf16_f32 v144, v48, v49
    v_cvt_pk_bf16_f32 v145, v50, v51
    v_cvt_pk_bf16_f32 v146, v52, v53
    v_cvt_pk_bf16_f32 v147, v54, v55
    v_cvt_pk_bf16_f32 v148, v56, v57
    v_cvt_pk_bf16_f32 v149, v58, v59
    v_mfma_f32_32x32x16_bf16 v[64:79], v[16:19], v[156:159], v[64:79]
    v_cvt_pk_bf16_f32 v150, v60, v61
    v_cvt_pk_bf16_f32 v151, v62, v63
    s_waitcnt lgkmcnt(2)
    v_mfma_f32_32x32x16_bf16 v[80:95], v[136:139], a[0:3], v[80:95]
    ds_read_b64_tr_b16 a[16:17], v10 offset:14336
    ds_read_b64_tr_b16 a[18:19], v10 offset:15360
    s_waitcnt lgkmcnt(2)
    v_mfma_f32_32x32x16_bf16 v[96:111], v[136:139], a[4:7], v[96:111]
    ds_read_b64_tr_b16 a[20:21], v11 offset:14336
    ds_read_b64_tr_b16 a[22:23], v11 offset:15360
    s_waitcnt lgkmcnt(2)
    v_mfma_f32_32x32x16_bf16 v[80:95], v[140:143], a[16:19], v[80:95]
    s_barrier
    ds_read_b64_tr_b16 a[0:1], v10 offset:16384
    ds_read_b64_tr_b16 a[2:3], v10 offset:17408
    s_waitcnt lgkmcnt(2)
    v_mfma_f32_32x32x16_bf16 v[96:111], v[140:143], a[20:23], v[96:111]
    ds_read_b64_tr_b16 a[4:5], v11 offset:16384
    ds_read_b64_tr_b16 a[6:7], v11 offset:17408
    v_mfma_f32_32x32x16_bf16 v[48:63], v[12:15], v[160:163], v[32:47]
    v_cvt_pk_bf16_f32 v152, v64, v65
    v_cvt_pk_bf16_f32 v153, v66, v67
    v_cvt_pk_bf16_f32 v154, v68, v69
    v_cvt_pk_bf16_f32 v155, v70, v71
    v_cvt_pk_bf16_f32 v156, v72, v73
    v_cvt_pk_bf16_f32 v157, v74, v75
    v_mfma_f32_32x32x16_bf16 v[48:63], v[16:19], v[164:167], v[48:63]
    v_cvt_pk_bf16_f32 v158, v76, v77
    v_cvt_pk_bf16_f32 v159, v78, v79
    s_waitcnt lgkmcnt(2)
    v_mfma_f32_32x32x16_bf16 v[80:95], v[144:147], a[0:3], v[80:95]
    ds_read_b64_tr_b16 a[16:17], v10 offset:18432
    ds_read_b64_tr_b16 a[18:19], v10 offset:19456
    s_waitcnt lgkmcnt(2)
    v_mfma_f32_32x32x16_bf16 v[96:111], v[144:147], a[4:7], v[96:111]
    ds_read_b64_tr_b16 a[20:21], v11 offset:18432
    ds_read_b64_tr_b16 a[22:23], v11 offset:19456
    s_waitcnt lgkmcnt(2)
    v_mfma_f32_32x32x16_bf16 v[80:95], v[148:151], a[16:19], v[80:95]
    ds_read_b64_tr_b16 a[0:1], v10 offset:20480
    ds_read_b64_tr_b16 a[2:3], v10 offset:21504
    s_waitcnt lgkmcnt(2)
    v_mfma_f32_32x32x16_bf16 v[96:111], v[148:151], a[20:23], v[96:111]
    ds_read_b64_tr_b16 a[4:5], v11 offset:20480
    ds_read_b64_tr_b16 a[6:7], v11 offset:21504
    v_mfma_f32_32x32x16_bf16 v[64:79], v[12:15], v[168:171], v[32:47]
    v_cvt_pk_bf16_f32 v160, v48, v49
    v_cvt_pk_bf16_f32 v161, v50, v51
    v_cvt_pk_bf16_f32 v162, v52, v53
    v_cvt_pk_bf16_f32 v163, v54, v55
    v_cvt_pk_bf16_f32 v164, v56, v57
    v_cvt_pk_bf16_f32 v165, v58, v59
    v_mfma_f32_32x32x16_bf16 v[64:79], v[16:19], v[172:175], v[64:79]
    v_cvt_pk_bf16_f32 v166, v60, v61
    v_cvt_pk_bf16_f32 v167, v62, v63
    s_waitcnt lgkmcnt(2)
    v_mfma_f32_32x32x16_bf16 v[80:95], v[152:155], a[0:3], v[80:95]
    ds_read_b64_tr_b16 a[16:17], v10 offset:22528
    ds_read_b64_tr_b16 a[18:19], v10 offset:23552
    s_waitcnt lgkmcnt(2)
    v_mfma_f32_32x32x16_bf16 v[96:111], v[152:155], a[4:7], v[96:111]
    ds_read_b64_tr_b16 a[20:21], v11 offset:22528
    ds_read_b64_tr_b16 a[22:23], v11 offset:23552
    s_waitcnt lgkmcnt(2)
    v_mfma_f32_32x32x16_bf16 v[80:95], v[156:159], a[16:19], v[80:95]
    ds_read_b64_tr_b16 a[0:1], v10 offset:24576
    ds_read_b64_tr_b16 a[2:3], v10 offset:25600
    s_waitcnt lgkmcnt(2)
    v_mfma_f32_32x32x16_bf16 v[96:111], v[156:159], a[20:23], v[96:111]
    ds_read_b64_tr_b16 a[4:5], v11 offset:24576
    ds_read_b64_tr_b16 a[6:7], v11 offset:25600
    v_mfma_f32_32x32x16_bf16 v[48:63], v[12:15], v[176:179], v[32:47]
    v_cvt_pk_bf16_f32 v168, v64, v65
    v_cvt_pk_bf16_f32 v169, v66, v67
    v_cvt_pk_bf16_f32 v170, v68, v69
    v_cvt_pk_bf16_f32 v171, v70, v71
    v_cvt_pk_bf16_f32 v172, v72, v73
    v_cvt_pk_bf16_f32 v173, v74, v75
    v_mfma_f32_32x32x16_bf16 v[48:63], v[16:19], v[180:183], v[48:63]
    v_cvt_pk_bf16_f32 v174, v76, v77
    v_cvt_pk_bf16_f32 v175, v78, v79
    s_waitcnt lgkmcnt(2)
    v_mfma_f32_32x32x16_bf16 v[80:95], v[160:163], a[0:3], v[80:95]
    ds_read_b64_tr_b16 a[16:17], v10 offset:26624
    ds_read_b64_tr_b16 a[18:19], v10 offset:27648
    s_waitcnt lgkmcnt(2)
    v_mfma_f32_32x32x16_bf16 v[96:111], v[160:163], a[4:7], v[96:111]
    ds_read_b64_tr_b16 a[20:21], v11 offset:26624
    ds_read_b64_tr_b16 a[22:23], v11 offset:27648
    s_waitcnt lgkmcnt(2)
    v_mfma_f32_32x32x16_bf16 v[80:95], v[164:167], a[16:19], v[80:95]
    ds_read_b64_tr_b16 a[0:1], v10 offset:28672
    ds_read_b64_tr_b16 a[2:3], v10 offset:29696
    s_waitcnt lgkmcnt(2)
    v_mfma_f32_32x32x16_bf16 v[96:111], v[164:167], a[20:23], v[96:111]
    ds_read_b64_tr_b16 a[4:5], v11 offset:28672
    ds_read_b64_tr_b16 a[6:7], v11 offset:29696
    v_mfma_f32_32x32x16_bf16 v[64:79], v[12:15], v[184:187], v[32:47]
    v_cvt_pk_bf16_f32 v176, v48, v49
    v_cvt_pk_bf16_f32 v177, v50, v51
    v_cvt_pk_bf16_f32 v178, v52, v53
    v_cvt_pk_bf16_f32 v179, v54, v55
    v_cvt_pk_bf16_f32 v180, v56, v57
    v_cvt_pk_bf16_f32 v181, v58, v59
    v_mfma_f32_32x32x16_bf16 v[64:79], v[16:19], v[188:191], v[64:79]
    v_cvt_pk_bf16_f32 v182, v60, v61
    v_cvt_pk_bf16_f32 v183, v62, v63
    s_waitcnt lgkmcnt(2)
    v_mfma_f32_32x32x16_bf16 v[80:95], v[168:171], a[0:3], v[80:95]
    ds_read_b64_tr_b16 a[16:17], v10 offset:30720
    ds_read_b64_tr_b16 a[18:19], v10 offset:31744
    s_waitcnt lgkmcnt(2)
    v_mfma_f32_32x32x16_bf16 v[96:111], v[168:171], a[4:7], v[96:111]
    ds_read_b64_tr_b16 a[20:21], v11 offset:30720
    ds_read_b64_tr_b16 a[22:23], v11 offset:31744
    s_waitcnt lgkmcnt(2)
    v_mfma_f32_32x32x16_bf16 v[80:95], v[172:175], a[16:19], v[80:95]
    s_barrier
    ds_read_b64_tr_b16 a[0:1], v10 offset:32768
    ds_read_b64_tr_b16 a[2:3], v10 offset:33792
    s_waitcnt lgkmcnt(2)
    v_mfma_f32_32x32x16_bf16 v[96:111], v[172:175], a[20:23], v[96:111]
    ds_read_b64_tr_b16 a[4:5], v11 offset:32768
    ds_read_b64_tr_b16 a[6:7], v11 offset:33792
    v_mfma_f32_32x32x16_bf16 v[48:63], v[12:15], v[192:195], v[32:47]
    v_cvt_pk_bf16_f32 v184, v64, v65
    v_cvt_pk_bf16_f32 v185, v66, v67
    v_cvt_pk_bf16_f32 v186, v68, v69
    v_cvt_pk_bf16_f32 v187, v70, v71
    v_cvt_pk_bf16_f32 v188, v72, v73
    v_cvt_pk_bf16_f32 v189, v74, v75
    v_mfma_f32_32x32x16_bf16 v[48:63], v[16:19], v[196:199], v[48:63]
    v_cvt_pk_bf16_f32 v190, v76, v77
    v_cvt_pk_bf16_f32 v191, v78, v79
    s_waitcnt lgkmcnt(2)
    v_mfma_f32_32x32x16_bf16 v[80:95], v[176:179], a[0:3], v[80:95]
    ds_read_b64_tr_b16 a[16:17], v10 offset:34816
    ds_read_b64_tr_b16 a[18:19], v10 offset:35840
    s_waitcnt lgkmcnt(2)
    v_mfma_f32_32x32x16_bf16 v[96:111], v[176:179], a[4:7], v[96:111]
    ds_read_b64_tr_b16 a[20:21], v11 offset:34816
    ds_read_b64_tr_b16 a[22:23], v11 offset:35840
    s_waitcnt lgkmcnt(2)
    v_mfma_f32_32x32x16_bf16 v[80:95], v[180:183], a[16:19], v[80:95]
    ds_read_b64_tr_b16 a[0:1], v10 offset:36864
    ds_read_b64_tr_b16 a[2:3], v10 offset:37888
    s_waitcnt lgkmcnt(2)
    v_mfma_f32_32x32x16_bf16 v[96:111], v[180:183], a[20:23], v[96:111]
    ds_read_b64_tr_b16 a[4:5], v11 offset:36864
    ds_read_b64_tr_b16 a[6:7], v11 offset:37888
    v_mfma_f32_32x32x16_bf16 v[64:79], v[12:15], v[200:203], v[32:47]
    v_cvt_pk_bf16_f32 v192, v48, v49
    v_cvt_pk_bf16_f32 v193, v50, v51
    v_cvt_pk_bf16_f32 v194, v52, v53
    v_cvt_pk_bf16_f32 v195, v54, v55
    v_cvt_pk_bf16_f32 v196, v56, v57
    v_cvt_pk_bf16_f32 v197, v58, v59
    v_mfma_f32_32x32x16_bf16 v[64:79], v[16:19], v[204:207], v[64:79]
    v_cvt_pk_bf16_f32 v198, v60, v61
    v_cvt_pk_bf16_f32 v199, v62, v63
    s_waitcnt lgkmcnt(2)
    v_mfma_f32_32x32x16_bf16 v[80:95], v[184:187], a[0:3], v[80:95]
    ds_read_b64_tr_b16 a[16:17], v10 offset:38912
    ds_read_b64_tr_b16 a[18:19], v10 offset:39936
    s_waitcnt lgkmcnt(2)
    v_mfma_f32_32x32x16_bf16 v[96:111], v[184:187], a[4:7], v[96:111]
    ds_read_b64_tr_b16 a[20:21], v11 offset:38912
    ds_read_b64_tr_b16 a[22:23], v11 offset:39936
    s_waitcnt lgkmcnt(2)
    v_mfma_f32_32x32x16_bf16 v[80:95], v[188:191], a[16:19], v[80:95]
    ds_read_b64_tr_b16 a[0:1], v10 offset:40960
    ds_read_b64_tr_b16 a[2:3], v10 offset:41984
    s_waitcnt lgkmcnt(2)
    v_mfma_f32_32x32x16_bf16 v[96:111], v[188:191], a[20:23], v[96:111]
    ds_read_b64_tr_b16 a[4:5], v11 offset:40960
    ds_read_b64_tr_b16 a[6:7], v11 offset:41984
    v_mfma_f32_32x32x16_bf16 v[48:63], v[12:15], v[208:211], v[32:47]
    v_cvt_pk_bf16_f32 v200, v64, v65
    v_cvt_pk_bf16_f32 v201, v66, v67
    v_cvt_pk_bf16_f32 v202, v68, v69
    v_cvt_pk_bf16_f32 v203, v70, v71
    v_cvt_pk_bf16_f32 v204, v72, v73
    v_cvt_pk_bf16_f32 v205, v74, v75
    v_mfma_f32_32x32x16_bf16 v[48:63], v[16:19], v[212:215], v[48:63]
    v_cvt_pk_bf16_f32 v206, v76, v77
    v_cvt_pk_bf16_f32 v207, v78, v79
    s_waitcnt lgkmcnt(2)
    v_mfma_f32_32x32x16_bf16 v[80:95], v[192:195], a[0:3], v[80:95]
    ds_read_b64_tr_b16 a[16:17], v10 offset:43008
    ds_read_b64_tr_b16 a[18:19], v10 offset:44032
    s_waitcnt lgkmcnt(2)
    v_mfma_f32_32x32x16_bf16 v[96:111], v[192:195], a[4:7], v[96:111]
    ds_read_b64_tr_b16 a[20:21], v11 offset:43008
    ds_read_b64_tr_b16 a[22:23], v11 offset:44032
    s_waitcnt lgkmcnt(2)
    v_mfma_f32_32x32x16_bf16 v[80:95], v[196:199], a[16:19], v[80:95]
    ds_read_b64_tr_b16 a[0:1], v10 offset:49152
    ds_read_b64_tr_b16 a[2:3], v10 offset:50176
    s_waitcnt lgkmcnt(2)
    v_mfma_f32_32x32x16_bf16 v[96:111], v[196:199], a[20:23], v[96:111]
    ds_read_b64_tr_b16 a[4:5], v11 offset:49152
    ds_read_b64_tr_b16 a[6:7], v11 offset:50176
    v_mfma_f32_32x32x16_bf16 v[64:79], v[12:15], v[216:219], v[32:47]
    v_cvt_pk_bf16_f32 v208, v48, v49
    v_cvt_pk_bf16_f32 v209, v50, v51
    v_cvt_pk_bf16_f32 v210, v52, v53
    v_cvt_pk_bf16_f32 v211, v54, v55
    v_cvt_pk_bf16_f32 v212, v56, v57
    v_cvt_pk_bf16_f32 v213, v58, v59
    v_mfma_f32_32x32x16_bf16 v[64:79], v[16:19], v[220:223], v[64:79]
    v_cvt_pk_bf16_f32 v214, v60, v61
    v_cvt_pk_bf16_f32 v215, v62, v63
    s_waitcnt lgkmcnt(2)
    v_mfma_f32_32x32x16_bf16 v[80:95], v[200:203], a[0:3], v[80:95]
    ds_read_b64_tr_b16 a[16:17], v10 offset:51200
    ds_read_b64_tr_b16 a[18:19], v10 offset:52224
    s_waitcnt lgkmcnt(2)
    v_mfma_f32_32x32x16_bf16 v[96:111], v[200:203], a[4:7], v[96:111]
    ds_read_b64_tr_b16 a[20:21], v11 offset:51200
    ds_read_b64_tr_b16 a[22:23], v11 offset:52224
    s_waitcnt lgkmcnt(2)
    v_mfma_f32_32x32x16_bf16 v[80:95], v[204:207], a[16:19], v[80:95]
    s_barrier
    ds_read_b64_tr_b16 a[0:1], v10 offset:53248
    ds_read_b64_tr_b16 a[2:3], v10 offset:54272
    s_waitcnt lgkmcnt(2)
    v_mfma_f32_32x32x16_bf16 v[96:111], v[204:207], a[20:23], v[96:111]
    ds_read_b64_tr_b16 a[4:5], v11 offset:53248
    ds_read_b64_tr_b16 a[6:7], v11 offset:54272
    s_waitcnt lgkmcnt(2)
    v_mfma_f32_32x32x16_bf16 v[80:95], v[208:211], a[0:3], v[80:95]
    ds_read_b64_tr_b16 a[16:17], v10 offset:55296
    ds_read_b64_tr_b16 a[18:19], v10 offset:56320
    v_cvt_pk_bf16_f32 v216, v64, v65
    v_cvt_pk_bf16_f32 v217, v66, v67
    v_cvt_pk_bf16_f32 v218, v68, v69
    s_waitcnt lgkmcnt(2)
    v_mfma_f32_32x32x16_bf16 v[96:111], v[208:211], a[4:7], v[96:111]
    ds_read_b64_tr_b16 a[20:21], v11 offset:55296
    ds_read_b64_tr_b16 a[22:23], v11 offset:56320
    v_cvt_pk_bf16_f32 v219, v70, v71
    v_cvt_pk_bf16_f32 v220, v72, v73
    v_cvt_pk_bf16_f32 v221, v74, v75
    s_waitcnt lgkmcnt(2)
    v_mfma_f32_32x32x16_bf16 v[80:95], v[212:215], a[16:19], v[80:95]
    ds_read_b64_tr_b16 a[0:1], v10 offset:57344
    ds_read_b64_tr_b16 a[2:3], v10 offset:58368
    v_cvt_pk_bf16_f32 v222, v76, v77
    v_cvt_pk_bf16_f32 v223, v78, v79
    s_waitcnt lgkmcnt(2)
    v_mfma_f32_32x32x16_bf16 v[96:111], v[212:215], a[20:23], v[96:111]
    ds_read_b64_tr_b16 a[4:5], v11 offset:57344
    ds_read_b64_tr_b16 a[6:7], v11 offset:58368
    s_waitcnt lgkmcnt(2)
    v_mfma_f32_32x32x16_bf16 v[80:95], v[216:219], a[0:3], v[80:95]
    ds_read_b64_tr_b16 a[16:17], v10 offset:59392
    ds_read_b64_tr_b16 a[18:19], v10 offset:60416
    ds_read_b128 v[48:51], v4 offset:0
    ds_read_b128 v[52:55], v4 offset:32
    ds_read_b128 v[56:59], v4 offset:64
    s_waitcnt lgkmcnt(5)
    v_mfma_f32_32x32x16_bf16 v[96:111], v[216:219], a[4:7], v[96:111]
    ds_read_b64_tr_b16 a[20:21], v11 offset:59392
    ds_read_b64_tr_b16 a[22:23], v11 offset:60416
    ds_read_b128 v[60:63], v4 offset:96
    ds_read_b128 v[64:67], v4 offset:128
    ds_read_b128 v[68:71], v4 offset:160
    s_waitcnt lgkmcnt(8)
    v_mfma_f32_32x32x16_bf16 v[80:95], v[220:223], a[16:19], v[80:95]
    s_barrier
    s_waitcnt lgkmcnt(3)
    v_mfma_f32_32x32x16_bf16 v[96:111], v[220:223], a[20:23], v[96:111]
    ds_read_b128 v[72:75], v4 offset:192
    ds_read_b128 v[76:79], v4 offset:224
    v_mov_b32 v31, 0
    global_load_dword v30, v31, s[20:21] sc1
    s_cmp_eq_u32 s55, 7
    s_cbranch_scc1 L_raq
    v_bfe_u32 v39, v0, 2, 2
    v_bfe_u32 v37, v0, 4, 1
    v_lshrrev_b32 v36, 5, v0
    v_lshl_add_u32 v36, v36, 2, v39
    v_and_b32 v38, 3, v0
    v_lshlrev_b32 v38, 3, v38
    v_lshrrev_b32 v35, 1, v39
    v_lshl_or_b32 v35, v37, 1, v35
    v_lshlrev_b32 v32, 10, v37
    v_lshl_add_u32 v32, v36, 7, v32
    v_add_u32 v32, v32, v38
    v_xor_b32 v33, 0, v35
    v_lshl_add_u32 v12, v33, 5, v32
    v_xor_b32 v33, 1, v35
    v_lshl_add_u32 v13, v33, 5, v32
    v_xor_b32 v33, 2, v35
    v_lshl_add_u32 v14, v33, 5, v32
    v_xor_b32 v33, 3, v35
    v_lshl_add_u32 v15, v33, 5, v32
    s_branch L_rad
L_raq:
    v_bfe_u32 v39, v0, 2, 2
    v_bfe_u32 v37, v0, 4, 1
    v_lshrrev_b32 v36, 5, v0
    v_lshl_add_u32 v36, v36, 2, v39
    v_and_b32 v38, 3, v0
    v_lshlrev_b32 v38, 3, v38
    v_lshl_add_u32 v32, v37, 5, v38
    v_lshl_add_u32 v32, v39, 6, v32
    v_lshlrev_b32 v34, 8, v36
    v_add_u32 v33, 0, v32
    v_and_b32 v33, 255, v33
    v_add_u32 v12, v33, v34
    v_add_u32 v33, 56, v32
    v_and_b32 v33, 255, v33
    v_add_u32 v13, v33, v34
    v_add_u32 v33, 112, v32
    v_and_b32 v33, 255, v33
    v_add_u32 v14, v33, v34
    v_add_u32 v33, 168, v32
    v_and_b32 v33, 255, v33
    v_add_u32 v15, v33, v34
L_rad:
    v_add_u32 v16, 0x10000, v12
    v_add_u32 v17, 0x10000, v13
    v_add_u32 v18, 0x10000, v14
    v_add_u32 v19, 0x10000, v15
    v_add_u32 v20, 0x20000, v12
    v_add_u32 v21, 0x20000, v13
    v_add_u32 v22, 0x20000, v14
    v_add_u32 v23, 0x20000, v15
    s_waitcnt lgkmcnt(0)
    ds_read_b64_tr_b16 a[0:1], v16 offset:0
    ds_read_b64_tr_b16 a[2:3], v16 offset:2048
    ds_read_b64_tr_b16 a[4:5], v17 offset:0
    ds_read_b64_tr_b16 a[6:7], v17 offset:2048
    ds_read_b64_tr_b16 a[8:9], v18 offset:0
    ds_read_b64_tr_b16 a[10:11], v18 offset:2048
    ds_read_b64_tr_b16 a[12:13], v19 offset:0
    ds_read_b64_tr_b16 a[14:15], v19 offset:2048
    v_mul_f32 v32, v80, v64
    v_mul_f32 v33, v81, v65
    v_mul_f32 v34, v82, v66
    v_mul_f32 v35, v83, v67
    v_mul_f32 v36, v84, v68
    v_mul_f32 v37, v85, v69
    v_mul_f32 v38, v86, v70
    v_mul_f32 v39, v87, v71
    v_exp_f32_e64 v32, v32 clamp
    v_fmaak_f32 v80, v80, v48, 0x358637bd
    v_exp_f32_e64 v33, v33 clamp
    v_fmaak_f32 v81, v81, v49, 0x358637bd
    v_exp_f32_e64 v34, v34 clamp
    v_fmaak_f32 v82, v82, v50, 0x358637bd
    v_exp_f32_e64 v35, v35 clamp
    v_fmaak_f32 v83, v83, v51, 0x358637bd
    v_exp_f32_e64 v36, v36 clamp
    v_fmaak_f32 v84, v84, v52, 0x358637bd
    v_exp_f32_e64 v37, v37 clamp
    v_fmaak_f32 v85, v85, v53, 0x358637bd
    v_exp_f32_e64 v38, v38 clamp
    v_fmaak_f32 v86, v86, v54, 0x358637bd
    v_exp_f32_e64 v39, v39 clamp
    v_fmaak_f32 v87, v87, v55, 0x358637bd
    v_max_f32 v80, 0x358637bd, v80
    v_max_f32 v81, 0x358637bd, v81
    v_max_f32 v82, 0x358637bd, v82
    v_max_f32 v83, 0x358637bd, v83
    v_max_f32 v84, 0x358637bd, v84
    v_max_f32 v85, 0x358637bd, v85
    v_max_f32 v86, 0x358637bd, v86
    v_max_f32 v87, 0x358637bd, v87
    v_mul_f32 v96, v96, v48
    v_mul_f32 v97, v97, v49
    v_mul_f32 v98, v98, v50
    v_mul_f32 v99, v99, v51
    v_mul_f32 v100, v100, v52
    v_mul_f32 v101, v101, v53
    v_mul_f32 v102, v102, v54
    v_mul_f32 v103, v103, v55
    v_add_f32 v80, v80, v32
    v_add_f32 v81, v81, v33
    v_add_f32 v82, v82, v34
    v_add_f32 v83, v83, v35
    v_add_f32 v84, v84, v36
    v_add_f32 v85, v85, v37
    v_add_f32 v86, v86, v38
    v_add_f32 v87, v87, v39
    v_mul_f32 v32, v88, v72
    v_mul_f32 v33, v89, v73
    v_mul_f32 v34, v90, v74
    v_mul_f32 v35, v91, v75
    v_mul_f32 v36, v92, v76
    v_mul_f32 v37, v93, v77
    v_mul_f32 v38, v94, v78
    v_mul_f32 v39, v95, v79
    v_exp_f32_e64 v32, v32 clamp
    v_fmaak_f32 v88, v88, v56, 0x358637bd
    v_exp_f32_e64 v33, v33 clamp
    v_fmaak_f32 v89, v89, v57, 0x358637bd
    v_exp_f32_e64 v34, v34 clamp
    v_fmaak_f32 v90, v90, v58, 0x358637bd
    v_exp_f32_e64 v35, v35 clamp
    v_fmaak_f32 v91, v91, v59, 0x358637bd
    v_exp_f32_e64 v36, v36 clamp
    v_fmaak_f32 v92, v92, v60, 0x358637bd
    v_exp_f32_e64 v37, v37 clamp
    v_fmaak_f32 v93, v93, v61, 0x358637bd
    v_exp_f32_e64 v38, v38 clamp
    v_fmaak_f32 v94, v94, v62, 0x358637bd
    v_exp_f32_e64 v39, v39 clamp
    v_fmaak_f32 v95, v95, v63, 0x358637bd
    v_max_f32 v88, 0x358637bd, v88
    v_max_f32 v89, 0x358637bd, v89
    v_max_f32 v90, 0x358637bd, v90
    v_max_f32 v91, 0x358637bd, v91
    v_max_f32 v92, 0x358637bd, v92
    v_max_f32 v93, 0x358637bd, v93
    v_max_f32 v94, 0x358637bd, v94
    v_max_f32 v95, 0x358637bd, v95
    v_mul_f32 v104, v104, v56
    v_mul_f32 v105, v105, v57
    v_mul_f32 v106, v106, v58
    v_mul_f32 v107, v107, v59
    v_mul_f32 v108, v108, v60
    v_mul_f32 v109, v109, v61
    v_mul_f32 v110, v110, v62
    v_mul_f32 v111, v111, v63
    v_add_f32 v88, v88, v32
    v_add_f32 v89, v89, v33
    v_add_f32 v90, v90, v34
    v_add_f32 v91, v91, v35
    v_add_f32 v92, v92, v36
    v_add_f32 v93, v93, v37
    v_add_f32 v94, v94, v38
    v_add_f32 v95, v95, v39
    v_and_b32 v32, 31, v0
    v_cmp_gt_u32 vcc, 28, v32
    v_cvt_pk_bf16_f32 v64, v96, v97
    v_cvt_pk_bf16_f32 v40, v80, v81
    v_cvt_pk_bf16_f32 v65, v98, v99
    v_cvt_pk_bf16_f32 v41, v82, v83
    v_cvt_pk_bf16_f32 v66, v100, v101
    v_cvt_pk_bf16_f32 v42, v84, v85
    v_cvt_pk_bf16_f32 v67, v102, v103
    v_cvt_pk_bf16_f32 v43, v86, v87
    v_cvt_pk_bf16_f32 v68, v104, v105
    v_cvt_pk_bf16_f32 v44, v88, v89
    v_cvt_pk_bf16_f32 v69, v106, v107
    v_cvt_pk_bf16_f32 v45, v90, v91
    v_cvt_pk_bf16_f32 v70, v108, v109
    v_cvt_pk_bf16_f32 v46, v92, v93
    v_cvt_pk_bf16_f32 v71, v110, v111
    v_cvt_pk_bf16_f32 v47, v94, v95
    v_cndmask_b32 v64, v29, v64, vcc
    v_cndmask_b32 v65, v29, v65, vcc
    v_cndmask_b32 v66, v29, v66, vcc
    v_cndmask_b32 v67, v29, v67, vcc
    v_cndmask_b32 v68, v29, v68, vcc
    v_cndmask_b32 v69, v29, v69, vcc
    v_cndmask_b32 v70, v29, v70, vcc
    v_cndmask_b32 v71, v29, v71, vcc
    s_lshl_b32 s64, s52, 12
    v_add_u32 v32, s64, v1
    v_mfma_f32_32x32x16_bf16 v[48:63], v[40:43], v[64:67], 0
    v_mfma_f32_32x32x16_bf16 v[48:63], v[44:47], v[68:71], v[48:63]
    s_barrier
    s_waitcnt vmcnt(0)
    v_cmp_eq_u32 vcc, 0, v30
    s_cbranch_vccnz LS_noncec
LB_noncec:
    s_nop 1
    v_readfirstlane_b32 s67, v30
    s_nop 1
    s_nop 2
    ds_write_b128 v32, v[48:51] offset:49152
    ds_write_b128 v32, v[52:55] offset:50176
    ds_write_b128 v32, v[56:59] offset:51200
    ds_write_b128 v32, v[60:63] offset:52224
    v_add_u32 v32, s63, v1
    s_lshl_b32 s64, s56, 4
    s_add_u32 s64, s64, s53
    s_lshl_b32 s64, s64, 12
    s_add_u32 s64, s64, s63
    s_add_u32 s66, s64, 0x900000
    s_waitcnt lgkmcnt(0)
    s_barrier
    ds_read_b128 v[80:83], v32 offset:49152
    ds_read_b128 v[84:87], v32 offset:53248
    ds_read_b128 v[88:91], v32 offset:57344
    ds_read_b128 v[92:95], v32 offset:61440
    s_waitcnt lgkmcnt(0)
    v_add_f32 v80, v80, v84
    v_add_f32 v88, v88, v92
    v_add_f32 v81, v81, v85
    v_add_f32 v89, v89, v93
    v_add_f32 v82, v82, v86
    v_add_f32 v90, v90, v94
    v_add_f32 v83, v83, v87
    v_add_f32 v91, v91, v95
    v_add_f32 v44, v80, v88
    v_add_f32 v45, v81, v89
    v_add_f32 v46, v82, v90
    v_add_f32 v47, v83, v91
    buffer_store_dwordx4 v[44:47], v1, s[36:39], s66 offen sc1
    v_mfma_f32_32x32x16_bf16 v[48:63], a[0:3], v[112:115], 0
    ds_read_b64_tr_b16 a[16:17], v16 offset:4096
    ds_read_b64_tr_b16 a[18:19], v16 offset:6144
    v_mfma_f32_32x32x16_bf16 v[64:79], a[4:7], v[112:115], 0
    ds_read_b64_tr_b16 a[20:21], v17 offset:4096
    ds_read_b64_tr_b16 a[22:23], v17 offset:6144
    v_mfma_f32_32x32x16_bf16 v[80:95], a[8:11], v[112:115], 0
    ds_read_b64_tr_b16 a[24:25], v18 offset:4096
    ds_read_b64_tr_b16 a[26:27], v18 offset:6144
    v_mfma_f32_32x32x16_bf16 v[96:111], a[12:15], v[112:115], 0
    ds_read_b64_tr_b16 a[28:29], v19 offset:4096
    ds_read_b64_tr_b16 a[30:31], v19 offset:6144
    s_waitcnt lgkmcnt(4)
    v_mfma_f32_32x32x16_bf16 v[48:63], a[16:19], v[116:119], v[48:63]
    ds_read_b64_tr_b16 a[0:1], v16 offset:8192
    ds_read_b64_tr_b16 a[2:3], v16 offset:10240
    v_mfma_f32_32x32x16_bf16 v[64:79], a[20:23], v[116:119], v[64:79]
    ds_read_b64_tr_b16 a[4:5], v17 offset:8192
    ds_read_b64_tr_b16 a[6:7], v17 offset:10240
    s_waitcnt lgkmcnt(4)
    v_mfma_f32_32x32x16_bf16 v[80:95], a[24:27], v[116:119], v[80:95]
    ds_read_b64_tr_b16 a[8:9], v18 offset:8192
    ds_read_b64_tr_b16 a[10:11], v18 offset:10240
    v_mfma_f32_32x32x16_bf16 v[96:111], a[28:31], v[116:119], v[96:111]
    ds_read_b64_tr_b16 a[12:13], v19 offset:8192
    ds_read_b64_tr_b16 a[14:15], v19 offset:10240
    s_waitcnt lgkmcnt(4)
    v_mfma_f32_32x32x16_bf16 v[48:63], a[0:3], v[120:123], v[48:63]
    ds_read_b64_tr_b16 a[16:17], v16 offset:12288
    ds_read_b64_tr_b16 a[18:19], v16 offset:14336
    v_mfma_f32_32x32x16_bf16 v[64:79], a[4:7], v[120:123], v[64:79]
    ds_read_b64_tr_b16 a[20:21], v17 offset:12288
    ds_read_b64_tr_b16 a[22:23], v17 offset:14336
    s_waitcnt lgkmcnt(4)
    v_mfma_f32_32x32x16_bf16 v[80:95], a[8:11], v[120:123], v[80:95]
    ds_read_b64_tr_b16 a[24:25], v18 offset:12288
    ds_read_b64_tr_b16 a[26:27], v18 offset:14336
    v_mfma_f32_32x32x16_bf16 v[96:111], a[12:15], v[120:123], v[96:111]
    ds_read_b64_tr_b16 a[28:29], v19 offset:12288
    ds_read_b64_tr_b16 a[30:31], v19 offset:14336
    s_waitcnt lgkmcnt(4)
    v_mfma_f32_32x32x16_bf16 v[48:63], a[16:19], v[124:127], v[48:63]
    s_barrier
    v_mfma_f32_32x32x16_bf16 v[64:79], a[20:23], v[124:127], v[64:79]
    ds_read_b64_tr_b16 a[0:1], v16 offset:16384
    ds_read_b64_tr_b16 a[2:3], v16 offset:18432
    ds_read_b64_tr_b16 a[4:5], v17 offset:16384
    ds_read_b64_tr_b16 a[6:7], v17 offset:18432
    s_waitcnt lgkmcnt(4)
    v_mfma_f32_32x32x16_bf16 v[80:95], a[24:27], v[124:127], v[80:95]
    ds_read_b64_tr_b16 a[8:9], v18 offset:16384
    ds_read_b64_tr_b16 a[10:11], v18 offset:18432
    v_mfma_f32_32x32x16_bf16 v[96:111], a[28:31], v[124:127], v[96:111]
    ds_read_b64_tr_b16 a[12:13], v19 offset:16384
    ds_read_b64_tr_b16 a[14:15], v19 offset:18432
    s_waitcnt lgkmcnt(4)
    v_mfma_f32_32x32x16_bf16 v[48:63], a[0:3], v[128:131], v[48:63]
    ds_read_b64_tr_b16 a[16:17], v16 offset:20480
    ds_read_b64_tr_b16 a[18:19], v16 offset:22528
    s_lshl_b32 s64, s56, 2
    s_add_u32 s64, s64, s52
    s_lshl_b32 s64, s64, 5
    v_mfma_f32_32x32x16_bf16 v[64:79], a[4:7], v[128:131], v[64:79]
    ds_read_b64_tr_b16 a[20:21], v17 offset:20480
    ds_read_b64_tr_b16 a[22:23], v17 offset:22528
    s_add_u32 s64, s64, s53
    s_lshl_b32 s64, s64, 2
    s_waitcnt lgkmcnt(4)
    v_mfma_f32_32x32x16_bf16 v[80:95], a[8:11], v[128:131], v[80:95]
    ds_read_b64_tr_b16 a[24:25], v18 offset:20480
    ds_read_b64_tr_b16 a[26:27], v18 offset:22528
    s_add_u32 s64, s64, 0xa10000
    s_waitcnt vmcnt(0)
    buffer_store_dword v30, off, s[36:39], s64 offset:0 sc1
    v_mfma_f32_32x32x16_bf16 v[96:111], a[12:15], v[128:131], v[96:111]
    ds_read_b64_tr_b16 a[28:29], v19 offset:20480
    ds_read_b64_tr_b16 a[30:31], v19 offset:22528
    s_waitcnt lgkmcnt(4)
    v_mfma_f32_32x32x16_bf16 v[48:63], a[16:19], v[132:135], v[48:63]
    ds_read_b64_tr_b16 a[0:1], v16 offset:24576
    ds_read_b64_tr_b16 a[2:3], v16 offset:26624
    v_mfma_f32_32x32x16_bf16 v[64:79], a[20:23], v[132:135], v[64:79]
    ds_read_b64_tr_b16 a[4:5], v17 offset:24576
    ds_read_b64_tr_b16 a[6:7], v17 offset:26624
    s_waitcnt lgkmcnt(4)
    v_mfma_f32_32x32x16_bf16 v[80:95], a[24:27], v[132:135], v[80:95]
    ds_read_b64_tr_b16 a[8:9], v18 offset:24576
    ds_read_b64_tr_b16 a[10:11], v18 offset:26624
    v_mfma_f32_32x32x16_bf16 v[96:111], a[28:31], v[132:135], v[96:111]
    ds_read_b64_tr_b16 a[12:13], v19 offset:24576
    ds_read_b64_tr_b16 a[14:15], v19 offset:26624
    s_waitcnt lgkmcnt(4)
    v_mfma_f32_32x32x16_bf16 v[48:63], a[0:3], v[136:139], v[48:63]
    ds_read_b64_tr_b16 a[16:17], v16 offset:28672
    ds_read_b64_tr_b16 a[18:19], v16 offset:30720
    v_mfma_f32_32x32x16_bf16 v[64:79], a[4:7], v[136:139], v[64:79]
    ds_read_b64_tr_b16 a[20:21], v17 offset:28672
    ds_read_b64_tr_b16 a[22:23], v17 offset:30720
    s_waitcnt lgkmcnt(4)
    v_mfma_f32_32x32x16_bf16 v[80:95], a[8:11], v[136:139], v[80:95]
    ds_read_b64_tr_b16 a[24:25], v18 offset:28672
    ds_read_b64_tr_b16 a[26:27], v18 offset:30720
    v_mfma_f32_32x32x16_bf16 v[96:111], a[12:15], v[136:139], v[96:111]
    ds_read_b64_tr_b16 a[28:29], v19 offset:28672
    ds_read_b64_tr_b16 a[30:31], v19 offset:30720
    s_waitcnt lgkmcnt(4)
    v_mfma_f32_32x32x16_bf16 v[48:63], a[16:19], v[140:143], v[48:63]
    s_barrier
    v_mfma_f32_32x32x16_bf16 v[64:79], a[20:23], v[140:143], v[64:79]
    ds_read_b64_tr_b16 a[0:1], v16 offset:32768
    ds_read_b64_tr_b16 a[2:3], v16 offset:34816
    ds_read_b64_tr_b16 a[4:5], v17 offset:32768
    ds_read_b64_tr_b16 a[6:7], v17 offset:34816
    s_waitcnt lgkmcnt(4)
    v_mfma_f32_32x32x16_bf16 v[80:95], a[24:27], v[140:143], v[80:95]
    ds_read_b64_tr_b16 a[8:9], v18 offset:32768
    ds_read_b64_tr_b16 a[10:11], v18 offset:34816
    v_mfma_f32_32x32x16_bf16 v[96:111], a[28:31], v[140:143], v[96:111]
    ds_read_b64_tr_b16 a[12:13], v19 offset:32768
    ds_read_b64_tr_b16 a[14:15], v19 offset:34816
    s_waitcnt lgkmcnt(4)
    v_mfma_f32_32x32x16_bf16 v[48:63], a[0:3], v[144:147], v[48:63]
    ds_read_b64_tr_b16 a[16:17], v16 offset:36864
    ds_read_b64_tr_b16 a[18:19], v16 offset:38912
    v_mfma_f32_32x32x16_bf16 v[64:79], a[4:7], v[144:147], v[64:79]
    ds_read_b64_tr_b16 a[20:21], v17 offset:36864
    ds_read_b64_tr_b16 a[22:23], v17 offset:38912
    s_waitcnt lgkmcnt(4)
    v_mfma_f32_32x32x16_bf16 v[80:95], a[8:11], v[144:147], v[80:95]
    ds_read_b64_tr_b16 a[24:25], v18 offset:36864
    ds_read_b64_tr_b16 a[26:27], v18 offset:38912
    v_mfma_f32_32x32x16_bf16 v[96:111], a[12:15], v[144:147], v[96:111]
    ds_read_b64_tr_b16 a[28:29], v19 offset:36864
    ds_read_b64_tr_b16 a[30:31], v19 offset:38912
    s_waitcnt lgkmcnt(4)
    v_mfma_f32_32x32x16_bf16 v[48:63], a[16:19], v[148:151], v[48:63]
    ds_read_b64_tr_b16 a[0:1], v16 offset:40960
    ds_read_b64_tr_b16 a[2:3], v16 offset:43008
    v_mfma_f32_32x32x16_bf16 v[64:79], a[20:23], v[148:151], v[64:79]
    ds_read_b64_tr_b16 a[4:5], v17 offset:40960
    ds_read_b64_tr_b16 a[6:7], v17 offset:43008
    s_waitcnt lgkmcnt(4)
    v_mfma_f32_32x32x16_bf16 v[80:95], a[24:27], v[148:151], v[80:95]
    ds_read_b64_tr_b16 a[8:9], v18 offset:40960
    ds_read_b64_tr_b16 a[10:11], v18 offset:43008
    v_mfma_f32_32x32x16_bf16 v[96:111], a[28:31], v[148:151], v[96:111]
    ds_read_b64_tr_b16 a[12:13], v19 offset:40960
    ds_read_b64_tr_b16 a[14:15], v19 offset:43008
    s_waitcnt lgkmcnt(4)
    v_mfma_f32_32x32x16_bf16 v[48:63], a[0:3], v[152:155], v[48:63]
    ds_read_b64_tr_b16 a[16:17], v16 offset:45056
    ds_read_b64_tr_b16 a[18:19], v16 offset:47104
    v_mfma_f32_32x32x16_bf16 v[64:79], a[4:7], v[152:155], v[64:79]
    ds_read_b64_tr_b16 a[20:21], v17 offset:45056
    ds_read_b64_tr_b16 a[22:23], v17 offset:47104
    s_waitcnt lgkmcnt(4)
    v_mfma_f32_32x32x16_bf16 v[80:95], a[8:11], v[152:155], v[80:95]
    ds_read_b64_tr_b16 a[24:25], v18 offset:45056
    ds_read_b64_tr_b16 a[26:27], v18 offset:47104
    v_mfma_f32_32x32x16_bf16 v[96:111], a[12:15], v[152:155], v[96:111]
    ds_read_b64_tr_b16 a[28:29], v19 offset:45056
    ds_read_b64_tr_b16 a[30:31], v19 offset:47104
    s_waitcnt lgkmcnt(4)
    v_mfma_f32_32x32x16_bf16 v[48:63], a[16:19], v[156:159], v[48:63]
    s_barrier
    v_mfma_f32_32x32x16_bf16 v[64:79], a[20:23], v[156:159], v[64:79]
    ds_read_b64_tr_b16 a[0:1], v16 offset:49152
    ds_read_b64_tr_b16 a[2:3], v16 offset:51200
    ds_read_b64_tr_b16 a[4:5], v17 offset:49152
    ds_read_b64_tr_b16 a[6:7], v17 offset:51200
    s_waitcnt lgkmcnt(4)
    v_mfma_f32_32x32x16_bf16 v[80:95], a[24:27], v[156:159], v[80:95]
    ds_read_b64_tr_b16 a[8:9], v18 offset:49152
    ds_read_b64_tr_b16 a[10:11], v18 offset:51200
    v_mfma_f32_32x32x16_bf16 v[96:111], a[28:31], v[156:159], v[96:111]
    ds_read_b64_tr_b16 a[12:13], v19 offset:49152
    ds_read_b64_tr_b16 a[14:15], v19 offset:51200
    s_waitcnt lgkmcnt(4)
    v_mfma_f32_32x32x16_bf16 v[48:63], a[0:3], v[160:163], v[48:63]
    ds_read_b64_tr_b16 a[16:17], v16 offset:53248
    ds_read_b64_tr_b16 a[18:19], v16 offset:55296
    v_mfma_f32_32x32x16_bf16 v[64:79], a[4:7], v[160:163], v[64:79]
    ds_read_b64_tr_b16 a[20:21], v17 offset:53248
    ds_read_b64_tr_b16 a[22:23], v17 offset:55296
    s_waitcnt lgkmcnt(4)
    v_mfma_f32_32x32x16_bf16 v[80:95], a[8:11], v[160:163], v[80:95]
    ds_read_b64_tr_b16 a[24:25], v18 offset:53248
    ds_read_b64_tr_b16 a[26:27], v18 offset:55296
    v_mfma_f32_32x32x16_bf16 v[96:111], a[12:15], v[160:163], v[96:111]
    ds_read_b64_tr_b16 a[28:29], v19 offset:53248
    ds_read_b64_tr_b16 a[30:31], v19 offset:55296
    s_waitcnt lgkmcnt(4)
    v_mfma_f32_32x32x16_bf16 v[48:63], a[16:19], v[164:167], v[48:63]
    ds_read_b64_tr_b16 a[0:1], v16 offset:57344
    ds_read_b64_tr_b16 a[2:3], v16 offset:59392
    v_mfma_f32_32x32x16_bf16 v[64:79], a[20:23], v[164:167], v[64:79]
    ds_read_b64_tr_b16 a[4:5], v17 offset:57344
    ds_read_b64_tr_b16 a[6:7], v17 offset:59392
    s_waitcnt lgkmcnt(4)
    v_mfma_f32_32x32x16_bf16 v[80:95], a[24:27], v[164:167], v[80:95]
    ds_read_b64_tr_b16 a[8:9], v18 offset:57344
    ds_read_b64_tr_b16 a[10:11], v18 offset:59392
    v_mfma_f32_32x32x16_bf16 v[96:111], a[28:31], v[164:167], v[96:111]
    ds_read_b64_tr_b16 a[12:13], v19 offset:57344
    ds_read_b64_tr_b16 a[14:15], v19 offset:59392
    s_waitcnt lgkmcnt(4)
    v_mfma_f32_32x32x16_bf16 v[48:63], a[0:3], v[168:171], v[48:63]
    ds_read_b64_tr_b16 a[16:17], v16 offset:61440
    ds_read_b64_tr_b16 a[18:19], v16 offset:63488
    v_mfma_f32_32x32x16_bf16 v[64:79], a[4:7], v[168:171], v[64:79]
    ds_read_b64_tr_b16 a[20:21], v17 offset:61440
    ds_read_b64_tr_b16 a[22:23], v17 offset:63488
    s_waitcnt lgkmcnt(4)
    v_mfma_f32_32x32x16_bf16 v[80:95], a[8:11], v[168:171], v[80:95]
    ds_read_b64_tr_b16 a[24:25], v18 offset:61440
    ds_read_b64_tr_b16 a[26:27], v18 offset:63488
    v_mfma_f32_32x32x16_bf16 v[96:111], a[12:15], v[168:171], v[96:111]
    ds_read_b64_tr_b16 a[28:29], v19 offset:61440
    ds_read_b64_tr_b16 a[30:31], v19 offset:63488
    s_waitcnt lgkmcnt(4)
    v_mfma_f32_32x32x16_bf16 v[48:63], a[16:19], v[172:175], v[48:63]
    s_barrier
    v_mfma_f32_32x32x16_bf16 v[64:79], a[20:23], v[172:175], v[64:79]
    ds_read_b64_tr_b16 a[0:1], v20 offset:0
    ds_read_b64_tr_b16 a[2:3], v20 offset:2048
    ds_read_b64_tr_b16 a[4:5], v21 offset:0
    ds_read_b64_tr_b16 a[6:7], v21 offset:2048
    s_waitcnt lgkmcnt(4)
    v_mfma_f32_32x32x16_bf16 v[80:95], a[24:27], v[172:175], v[80:95]
    ds_read_b64_tr_b16 a[8:9], v22 offset:0
    ds_read_b64_tr_b16 a[10:11], v22 offset:2048
    v_mfma_f32_32x32x16_bf16 v[96:111], a[28:31], v[172:175], v[96:111]
    ds_read_b64_tr_b16 a[12:13], v23 offset:0
    ds_read_b64_tr_b16 a[14:15], v23 offset:2048
    s_waitcnt lgkmcnt(4)
    v_mfma_f32_32x32x16_bf16 v[48:63], a[0:3], v[176:179], v[48:63]
    ds_read_b64_tr_b16 a[16:17], v20 offset:4096
    ds_read_b64_tr_b16 a[18:19], v20 offset:6144
    v_mfma_f32_32x32x16_bf16 v[64:79], a[4:7], v[176:179], v[64:79]
    ds_read_b64_tr_b16 a[20:21], v21 offset:4096
    ds_read_b64_tr_b16 a[22:23], v21 offset:6144
    s_waitcnt lgkmcnt(4)
    v_mfma_f32_32x32x16_bf16 v[80:95], a[8:11], v[176:179], v[80:95]
    ds_read_b64_tr_b16 a[24:25], v22 offset:4096
    ds_read_b64_tr_b16 a[26:27], v22 offset:6144
    v_mfma_f32_32x32x16_bf16 v[96:111], a[12:15], v[176:179], v[96:111]
    ds_read_b64_tr_b16 a[28:29], v23 offset:4096
    ds_read_b64_tr_b16 a[30:31], v23 offset:6144
    s_waitcnt lgkmcnt(4)
    v_mfma_f32_32x32x16_bf16 v[48:63], a[16:19], v[180:183], v[48:63]
    ds_read_b64_tr_b16 a[0:1], v20 offset:8192
    ds_read_b64_tr_b16 a[2:3], v20 offset:10240
    v_mfma_f32_32x32x16_bf16 v[64:79], a[20:23], v[180:183], v[64:79]
    ds_read_b64_tr_b16 a[4:5], v21 offset:8192
    ds_read_b64_tr_b16 a[6:7], v21 offset:10240
    s_waitcnt lgkmcnt(4)
    v_mfma_f32_32x32x16_bf16 v[80:95], a[24:27], v[180:183], v[80:95]
    ds_read_b64_tr_b16 a[8:9], v22 offset:8192
    ds_read_b64_tr_b16 a[10:11], v22 offset:10240
    v_mfma_f32_32x32x16_bf16 v[96:111], a[28:31], v[180:183], v[96:111]
    ds_read_b64_tr_b16 a[12:13], v23 offset:8192
    ds_read_b64_tr_b16 a[14:15], v23 offset:10240
    s_waitcnt lgkmcnt(4)
    v_mfma_f32_32x32x16_bf16 v[48:63], a[0:3], v[184:187], v[48:63]
    ds_read_b64_tr_b16 a[16:17], v20 offset:12288
    ds_read_b64_tr_b16 a[18:19], v20 offset:14336
    v_mfma_f32_32x32x16_bf16 v[64:79], a[4:7], v[184:187], v[64:79]
    ds_read_b64_tr_b16 a[20:21], v21 offset:12288
    ds_read_b64_tr_b16 a[22:23], v21 offset:14336
    s_waitcnt lgkmcnt(4)
    v_mfma_f32_32x32x16_bf16 v[80:95], a[8:11], v[184:187], v[80:95]
    ds_read_b64_tr_b16 a[24:25], v22 offset:12288
    ds_read_b64_tr_b16 a[26:27], v22 offset:14336
    v_mfma_f32_32x32x16_bf16 v[96:111], a[12:15], v[184:187], v[96:111]
    ds_read_b64_tr_b16 a[28:29], v23 offset:12288
    ds_read_b64_tr_b16 a[30:31], v23 offset:14336
    s_waitcnt lgkmcnt(4)
    v_mfma_f32_32x32x16_bf16 v[48:63], a[16:19], v[188:191], v[48:63]
    s_barrier
    v_mfma_f32_32x32x16_bf16 v[64:79], a[20:23], v[188:191], v[64:79]
    ds_read_b64_tr_b16 a[0:1], v20 offset:16384
    ds_read_b64_tr_b16 a[2:3], v20 offset:18432
    ds_read_b64_tr_b16 a[4:5], v21 offset:16384
    ds_read_b64_tr_b16 a[6:7], v21 offset:18432
    s_waitcnt lgkmcnt(4)
    v_mfma_f32_32x32x16_bf16 v[80:95], a[24:27], v[188:191], v[80:95]
    ds_read_b64_tr_b16 a[8:9], v22 offset:16384
    ds_read_b64_tr_b16 a[10:11], v22 offset:18432
    v_mfma_f32_32x32x16_bf16 v[96:111], a[28:31], v[188:191], v[96:111]
    ds_read_b64_tr_b16 a[12:13], v23 offset:16384
    ds_read_b64_tr_b16 a[14:15], v23 offset:18432
    s_waitcnt lgkmcnt(4)
    v_mfma_f32_32x32x16_bf16 v[48:63], a[0:3], v[192:195], v[48:63]
    ds_read_b64_tr_b16 a[16:17], v20 offset:20480
    ds_read_b64_tr_b16 a[18:19], v20 offset:22528
    v_mfma_f32_32x32x16_bf16 v[64:79], a[4:7], v[192:195], v[64:79]
    ds_read_b64_tr_b16 a[20:21], v21 offset:20480
    ds_read_b64_tr_b16 a[22:23], v21 offset:22528
    s_waitcnt lgkmcnt(4)
    v_mfma_f32_32x32x16_bf16 v[80:95], a[8:11], v[192:195], v[80:95]
    ds_read_b64_tr_b16 a[24:25], v22 offset:20480
    ds_read_b64_tr_b16 a[26:27], v22 offset:22528
    v_mfma_f32_32x32x16_bf16 v[96:111], a[12:15], v[192:195], v[96:111]
    ds_read_b64_tr_b16 a[28:29], v23 offset:20480
    ds_read_b64_tr_b16 a[30:31], v23 offset:22528
    s_waitcnt lgkmcnt(4)
    v_mfma_f32_32x32x16_bf16 v[48:63], a[16:19], v[196:199], v[48:63]
    ds_read_b64_tr_b16 a[0:1], v20 offset:24576
    ds_read_b64_tr_b16 a[2:3], v20 offset:26624
    v_mfma_f32_32x32x16_bf16 v[64:79], a[20:23], v[196:199], v[64:79]
    ds_read_b64_tr_b16 a[4:5], v21 offset:24576
    ds_read_b64_tr_b16 a[6:7], v21 offset:26624
    s_waitcnt lgkmcnt(4)
    v_mfma_f32_32x32x16_bf16 v[80:95], a[24:27], v[196:199], v[80:95]
    ds_read_b64_tr_b16 a[8:9], v22 offset:24576
    ds_read_b64_tr_b16 a[10:11], v22 offset:26624
    v_mfma_f32_32x32x16_bf16 v[96:111], a[28:31], v[196:199], v[96:111]
    ds_read_b64_tr_b16 a[12:13], v23 offset:24576
    ds_read_b64_tr_b16 a[14:15], v23 offset:26624
    s_waitcnt lgkmcnt(4)
    v_mfma_f32_32x32x16_bf16 v[48:63], a[0:3], v[200:203], v[48:63]
    ds_read_b64_tr_b16 a[16:17], v20 offset:28672
    ds_read_b64_tr_b16 a[18:19], v20 offset:30720
    v_mfma_f32_32x32x16_bf16 v[64:79], a[4:7], v[200:203], v[64:79]
    ds_read_b64_tr_b16 a[20:21], v21 offset:28672
    ds_read_b64_tr_b16 a[22:23], v21 offset:30720
    s_waitcnt lgkmcnt(4)
    v_mfma_f32_32x32x16_bf16 v[80:95], a[8:11], v[200:203], v[80:95]
    ds_read_b64_tr_b16 a[24:25], v22 offset:28672
    ds_read_b64_tr_b16 a[26:27], v22 offset:30720
    v_mfma_f32_32x32x16_bf16 v[96:111], a[12:15], v[200:203], v[96:111]
    ds_read_b64_tr_b16 a[28:29], v23 offset:28672
    ds_read_b64_tr_b16 a[30:31], v23 offset:30720
    s_waitcnt lgkmcnt(4)
    v_mfma_f32_32x32x16_bf16 v[48:63], a[16:19], v[204:207], v[48:63]
    s_barrier
    v_mfma_f32_32x32x16_bf16 v[64:79], a[20:23], v[204:207], v[64:79]
    ds_read_b64_tr_b16 a[0:1], v12 offset:0
    ds_read_b64_tr_b16 a[2:3], v12 offset:2048
    ds_read_b64_tr_b16 a[4:5], v13 offset:0
    ds_read_b64_tr_b16 a[6:7], v13 offset:2048
    s_waitcnt lgkmcnt(4)
    v_mfma_f32_32x32x16_bf16 v[80:95], a[24:27], v[204:207], v[80:95]
    ds_read_b64_tr_b16 a[8:9], v14 offset:0
    ds_read_b64_tr_b16 a[10:11], v14 offset:2048
    v_mfma_f32_32x32x16_bf16 v[96:111], a[28:31], v[204:207], v[96:111]
    ds_read_b64_tr_b16 a[12:13], v15 offset:0
    ds_read_b64_tr_b16 a[14:15], v15 offset:2048
    s_waitcnt lgkmcnt(4)
    v_mfma_f32_32x32x16_bf16 v[48:63], a[0:3], v[208:211], v[48:63]
    ds_read_b64_tr_b16 a[16:17], v12 offset:4096
    ds_read_b64_tr_b16 a[18:19], v12 offset:6144
    v_mfma_f32_32x32x16_bf16 v[64:79], a[4:7], v[208:211], v[64:79]
    ds_read_b64_tr_b16 a[20:21], v13 offset:4096
    ds_read_b64_tr_b16 a[22:23], v13 offset:6144
    s_waitcnt lgkmcnt(4)
    v_mfma_f32_32x32x16_bf16 v[80:95], a[8:11], v[208:211], v[80:95]
    ds_read_b64_tr_b16 a[24:25], v14 offset:4096
    ds_read_b64_tr_b16 a[26:27], v14 offset:6144
    v_mfma_f32_32x32x16_bf16 v[96:111], a[12:15], v[208:211], v[96:111]
    ds_read_b64_tr_b16 a[28:29], v15 offset:4096
    ds_read_b64_tr_b16 a[30:31], v15 offset:6144
    s_waitcnt lgkmcnt(4)
    v_mfma_f32_32x32x16_bf16 v[48:63], a[16:19], v[212:215], v[48:63]
    ds_read_b64_tr_b16 a[0:1], v12 offset:8192
    ds_read_b64_tr_b16 a[2:3], v12 offset:10240
    v_mfma_f32_32x32x16_bf16 v[64:79], a[20:23], v[212:215], v[64:79]
    ds_read_b64_tr_b16 a[4:5], v13 offset:8192
    ds_read_b64_tr_b16 a[6:7], v13 offset:10240
    s_waitcnt lgkmcnt(4)
    v_mfma_f32_32x32x16_bf16 v[80:95], a[24:27], v[212:215], v[80:95]
    ds_read_b64_tr_b16 a[8:9], v14 offset:8192
    ds_read_b64_tr_b16 a[10:11], v14 offset:10240
    v_mfma_f32_32x32x16_bf16 v[96:111], a[28:31], v[212:215], v[96:111]
    ds_read_b64_tr_b16 a[12:13], v15 offset:8192
    ds_read_b64_tr_b16 a[14:15], v15 offset:10240
    s_waitcnt lgkmcnt(4)
    v_mfma_f32_32x32x16_bf16 v[48:63], a[0:3], v[216:219], v[48:63]
    ds_read_b64_tr_b16 a[16:17], v12 offset:12288
    ds_read_b64_tr_b16 a[18:19], v12 offset:14336
    v_mfma_f32_32x32x16_bf16 v[64:79], a[4:7], v[216:219], v[64:79]
    ds_read_b64_tr_b16 a[20:21], v13 offset:12288
    ds_read_b64_tr_b16 a[22:23], v13 offset:14336
    s_waitcnt lgkmcnt(4)
    v_mfma_f32_32x32x16_bf16 v[80:95], a[8:11], v[216:219], v[80:95]
    ds_read_b64_tr_b16 a[24:25], v14 offset:12288
    ds_read_b64_tr_b16 a[26:27], v14 offset:14336
    v_mfma_f32_32x32x16_bf16 v[96:111], a[12:15], v[216:219], v[96:111]
    ds_read_b64_tr_b16 a[28:29], v15 offset:12288
    ds_read_b64_tr_b16 a[30:31], v15 offset:14336
    s_waitcnt lgkmcnt(4)
    v_mfma_f32_32x32x16_bf16 v[48:63], a[16:19], v[220:223], v[48:63]
    s_barrier
    v_mfma_f32_32x32x16_bf16 v[64:79], a[20:23], v[220:223], v[64:79]
    s_waitcnt lgkmcnt(0)
    v_mfma_f32_32x32x16_bf16 v[80:95], a[24:27], v[220:223], v[80:95]
    v_mfma_f32_32x32x16_bf16 v[96:111], a[28:31], v[220:223], v[96:111]
    s_cmp_eq_u32 s55, 7
    s_cbranch_scc1 L_attn
    ds_read_b64_tr_b16 a[0:1], v12 offset:16384
    ds_read_b64_tr_b16 a[2:3], v12 offset:18432
    ds_read_b64_tr_b16 a[4:5], v13 offset:16384
    ds_read_b64_tr_b16 a[6:7], v13 offset:18432
    ds_read_b64_tr_b16 a[8:9], v14 offset:16384
    ds_read_b64_tr_b16 a[10:11], v14 offset:18432
    ds_read_b64_tr_b16 a[12:13], v15 offset:16384
    ds_read_b64_tr_b16 a[14:15], v15 offset:18432
    s_mul_i32 s66, s57, 114688
    s_mul_i32 s64, s54, 57344
    s_add_u32 s66, s66, s64
    s_lshl_b32 s64, s55, 12
    s_add_u32 s66, s66, s64
    s_add_u32 s66, s66, 0
    v_mul_f32 v32, v48, v24
    v_mul_f32 v33, v49, v24
    v_mul_f32 v34, v50, v24
    v_mul_f32 v35, v51, v24
    v_mul_f32 v36, v52, v24
    v_mul_f32 v37, v53, v24
    v_mul_f32 v38, v54, v24
    v_mul_f32 v39, v55, v24
    v_exp_f32 v32, v32
    v_mul_f32 v48, v48, v56
    v_exp_f32 v33, v33
    v_mul_f32 v49, v49, v57
    v_exp_f32 v34, v34
    v_mul_f32 v50, v50, v58
    v_exp_f32 v35, v35
    v_mul_f32 v51, v51, v59
    v_exp_f32 v36, v36
    v_mul_f32 v52, v52, v60
    v_exp_f32 v37, v37
    v_mul_f32 v53, v53, v61
    v_exp_f32 v38, v38
    v_mul_f32 v54, v54, v62
    v_exp_f32 v39, v39
    v_mul_f32 v55, v55, v63
    v_fma_f32 v32, v32, v25, v25
    v_fma_f32 v33, v33, v25, v25
    v_fma_f32 v34, v34, v25, v25
    v_fma_f32 v35, v35, v25, v25
    v_fma_f32 v36, v36, v25, v25
    v_fma_f32 v37, v37, v25, v25
    v_fma_f32 v38, v38, v25, v25
    v_fma_f32 v39, v39, v25, v25
    v_rcp_f32 v32, v32
    v_rcp_f32 v33, v33
    v_rcp_f32 v34, v34
    v_rcp_f32 v35, v35
    v_rcp_f32 v36, v36
    v_rcp_f32 v37, v37
    v_rcp_f32 v38, v38
    v_rcp_f32 v39, v39
    v_mul_f32 v48, v48, v32
    v_mul_f32 v49, v49, v33
    v_mul_f32 v50, v50, v34
    v_mul_f32 v51, v51, v35
    v_mul_f32 v52, v52, v36
    v_mul_f32 v53, v53, v37
    v_mul_f32 v54, v54, v38
    v_mul_f32 v55, v55, v39
    v_cvt_pk_bf16_f32 v40, v48, v49
    v_cvt_pk_bf16_f32 v41, v50, v51
    v_cvt_pk_bf16_f32 v42, v52, v53
    v_cvt_pk_bf16_f32 v43, v54, v55
    buffer_store_dwordx4 v[40:43], v1, s[36:39], s66 offen offset:0 sc1
    v_mul_f32 v32, v64, v24
    v_mul_f32 v33, v65, v24
    v_mul_f32 v34, v66, v24
    v_mul_f32 v35, v67, v24
    v_mul_f32 v36, v68, v24
    v_mul_f32 v37, v69, v24
    v_mul_f32 v38, v70, v24
    v_mul_f32 v39, v71, v24
    v_exp_f32 v32, v32
    v_mul_f32 v64, v64, v72
    v_exp_f32 v33, v33
    v_mul_f32 v65, v65, v73
    v_exp_f32 v34, v34
    v_mul_f32 v66, v66, v74
    v_exp_f32 v35, v35
    v_mul_f32 v67, v67, v75
    v_exp_f32 v36, v36
    v_mul_f32 v68, v68, v76
    v_exp_f32 v37, v37
    v_mul_f32 v69, v69, v77
    v_exp_f32 v38, v38
    v_mul_f32 v70, v70, v78
    v_exp_f32 v39, v39
    v_mul_f32 v71, v71, v79
    v_fma_f32 v32, v32, v25, v25
    v_fma_f32 v33, v33, v25, v25
    v_fma_f32 v34, v34, v25, v25
    v_fma_f32 v35, v35, v25, v25
    v_fma_f32 v36, v36, v25, v25
    v_fma_f32 v37, v37, v25, v25
    v_fma_f32 v38, v38, v25, v25
    v_fma_f32 v39, v39, v25, v25
    v_rcp_f32 v32, v32
    v_rcp_f32 v33, v33
    v_rcp_f32 v34, v34
    v_rcp_f32 v35, v35
    v_rcp_f32 v36, v36
    v_rcp_f32 v37, v37
    v_rcp_f32 v38, v38
    v_rcp_f32 v39, v39
    v_mul_f32 v64, v64, v32
    v_mul_f32 v65, v65, v33
    v_mul_f32 v66, v66, v34
    v_mul_f32 v67, v67, v35
    v_mul_f32 v68, v68, v36
    v_mul_f32 v69, v69, v37
    v_mul_f32 v70, v70, v38
    v_mul_f32 v71, v71, v39
    v_cvt_pk_bf16_f32 v44, v64, v65
    v_cvt_pk_bf16_f32 v45, v66, v67
    v_cvt_pk_bf16_f32 v46, v68, v69
    v_cvt_pk_bf16_f32 v47, v70, v71
    buffer_store_dwordx4 v[44:47], v1, s[36:39], s66 offen offset:1024 sc1
    v_mul_f32 v32, v80, v24
    v_mul_f32 v33, v81, v24
    v_mul_f32 v34, v82, v24
    v_mul_f32 v35, v83, v24
    v_mul_f32 v36, v84, v24
    v_mul_f32 v37, v85, v24
    v_mul_f32 v38, v86, v24
    v_mul_f32 v39, v87, v24
    v_exp_f32 v32, v32
    v_mul_f32 v80, v80, v88
    v_exp_f32 v33, v33
    v_mul_f32 v81, v81, v89
    v_exp_f32 v34, v34
    v_mul_f32 v82, v82, v90
    v_exp_f32 v35, v35
    v_mul_f32 v83, v83, v91
    v_exp_f32 v36, v36
    v_mul_f32 v84, v84, v92
    v_exp_f32 v37, v37
    v_mul_f32 v85, v85, v93
    v_exp_f32 v38, v38
    v_mul_f32 v86, v86, v94
    v_exp_f32 v39, v39
    v_mul_f32 v87, v87, v95
    v_fma_f32 v32, v32, v25, v25
    v_fma_f32 v33, v33, v25, v25
    v_fma_f32 v34, v34, v25, v25
    v_fma_f32 v35, v35, v25, v25
    v_fma_f32 v36, v36, v25, v25
    v_fma_f32 v37, v37, v25, v25
    v_fma_f32 v38, v38, v25, v25
    v_fma_f32 v39, v39, v25, v25
    v_rcp_f32 v32, v32
    v_rcp_f32 v33, v33
    v_rcp_f32 v34, v34
    v_rcp_f32 v35, v35
    v_rcp_f32 v36, v36
    v_rcp_f32 v37, v37
    v_rcp_f32 v38, v38
    v_rcp_f32 v39, v39
    v_mul_f32 v80, v80, v32
    v_mul_f32 v81, v81, v33
    v_mul_f32 v82, v82, v34
    v_mul_f32 v83, v83, v35
    v_mul_f32 v84, v84, v36
    v_mul_f32 v85, v85, v37
    v_mul_f32 v86, v86, v38
    v_mul_f32 v87, v87, v39
    v_cvt_pk_bf16_f32 v40, v80, v81
    v_cvt_pk_bf16_f32 v41, v82, v83
    v_cvt_pk_bf16_f32 v42, v84, v85
    v_cvt_pk_bf16_f32 v43, v86, v87
    buffer_store_dwordx4 v[40:43], v1, s[36:39], s66 offen offset:2048 sc1
    v_mul_f32 v32, v96, v24
    v_mul_f32 v33, v97, v24
    v_mul_f32 v34, v98, v24
    v_mul_f32 v35, v99, v24
    v_mul_f32 v36, v100, v24
    v_mul_f32 v37, v101, v24
    v_mul_f32 v38, v102, v24
    v_mul_f32 v39, v103, v24
    v_exp_f32 v32, v32
    v_mul_f32 v96, v96, v104
    v_exp_f32 v33, v33
    v_mul_f32 v97, v97, v105
    v_exp_f32 v34, v34
    v_mul_f32 v98, v98, v106
    v_exp_f32 v35, v35
    v_mul_f32 v99, v99, v107
    v_exp_f32 v36, v36
    v_mul_f32 v100, v100, v108
    v_exp_f32 v37, v37
    v_mul_f32 v101, v101, v109
    v_exp_f32 v38, v38
    v_mul_f32 v102, v102, v110
    v_exp_f32 v39, v39
    v_mul_f32 v103, v103, v111
    v_fma_f32 v32, v32, v25, v25
    v_fma_f32 v33, v33, v25, v25
    v_fma_f32 v34, v34, v25, v25
    v_fma_f32 v35, v35, v25, v25
    v_fma_f32 v36, v36, v25, v25
    v_fma_f32 v37, v37, v25, v25
    v_fma_f32 v38, v38, v25, v25
    v_fma_f32 v39, v39, v25, v25
    v_rcp_f32 v32, v32
    v_rcp_f32 v33, v33
    v_rcp_f32 v34, v34
    v_rcp_f32 v35, v35
    v_rcp_f32 v36, v36
    v_rcp_f32 v37, v37
    v_rcp_f32 v38, v38
    v_rcp_f32 v39, v39
    v_mul_f32 v96, v96, v32
    v_mul_f32 v97, v97, v33
    v_mul_f32 v98, v98, v34
    v_mul_f32 v99, v99, v35
    v_mul_f32 v100, v100, v36
    v_mul_f32 v101, v101, v37
    v_mul_f32 v102, v102, v38
    v_mul_f32 v103, v103, v39
    v_cvt_pk_bf16_f32 v44, v96, v97
    v_cvt_pk_bf16_f32 v45, v98, v99
    v_cvt_pk_bf16_f32 v46, v100, v101
    v_cvt_pk_bf16_f32 v47, v102, v103
    buffer_store_dwordx4 v[44:47], v1, s[36:39], s66 offen offset:3072 sc1
    s_waitcnt lgkmcnt(4)
    v_mfma_f32_32x32x16_bf16 v[48:63], a[0:3], v[112:115], 0
    ds_read_b64_tr_b16 a[16:17], v12 offset:20480
    ds_read_b64_tr_b16 a[18:19], v12 offset:22528
    v_mfma_f32_32x32x16_bf16 v[64:79], a[4:7], v[112:115], 0
    ds_read_b64_tr_b16 a[20:21], v13 offset:20480
    ds_read_b64_tr_b16 a[22:23], v13 offset:22528
    s_waitcnt lgkmcnt(4)
    v_mfma_f32_32x32x16_bf16 v[80:95], a[8:11], v[112:115], 0
    ds_read_b64_tr_b16 a[24:25], v14 offset:20480
    ds_read_b64_tr_b16 a[26:27], v14 offset:22528
    v_mfma_f32_32x32x16_bf16 v[96:111], a[12:15], v[112:115], 0
    ds_read_b64_tr_b16 a[28:29], v15 offset:20480
    ds_read_b64_tr_b16 a[30:31], v15 offset:22528
    s_waitcnt lgkmcnt(4)
    v_mfma_f32_32x32x16_bf16 v[48:63], a[16:19], v[116:119], v[48:63]
    ds_read_b64_tr_b16 a[0:1], v12 offset:24576
    ds_read_b64_tr_b16 a[2:3], v12 offset:26624
    v_mfma_f32_32x32x16_bf16 v[64:79], a[20:23], v[116:119], v[64:79]
    ds_read_b64_tr_b16 a[4:5], v13 offset:24576
    ds_read_b64_tr_b16 a[6:7], v13 offset:26624
    s_waitcnt lgkmcnt(4)
    v_mfma_f32_32x32x16_bf16 v[80:95], a[24:27], v[116:119], v[80:95]
    ds_read_b64_tr_b16 a[8:9], v14 offset:24576
    ds_read_b64_tr_b16 a[10:11], v14 offset:26624
    v_mfma_f32_32x32x16_bf16 v[96:111], a[28:31], v[116:119], v[96:111]
    ds_read_b64_tr_b16 a[12:13], v15 offset:24576
    ds_read_b64_tr_b16 a[14:15], v15 offset:26624
    s_waitcnt lgkmcnt(4)
    v_mfma_f32_32x32x16_bf16 v[48:63], a[0:3], v[120:123], v[48:63]
    ds_read_b64_tr_b16 a[16:17], v12 offset:28672
    ds_read_b64_tr_b16 a[18:19], v12 offset:30720
    v_mfma_f32_32x32x16_bf16 v[64:79], a[4:7], v[120:123], v[64:79]
    ds_read_b64_tr_b16 a[20:21], v13 offset:28672
    ds_read_b64_tr_b16 a[22:23], v13 offset:30720
    s_waitcnt lgkmcnt(4)
    v_mfma_f32_32x32x16_bf16 v[80:95], a[8:11], v[120:123], v[80:95]
    ds_read_b64_tr_b16 a[24:25], v14 offset:28672
    ds_read_b64_tr_b16 a[26:27], v14 offset:30720
    v_mfma_f32_32x32x16_bf16 v[96:111], a[12:15], v[120:123], v[96:111]
    ds_read_b64_tr_b16 a[28:29], v15 offset:28672
    ds_read_b64_tr_b16 a[30:31], v15 offset:30720
    s_waitcnt lgkmcnt(4)
    v_mfma_f32_32x32x16_bf16 v[48:63], a[16:19], v[124:127], v[48:63]
    s_barrier
    v_mfma_f32_32x32x16_bf16 v[64:79], a[20:23], v[124:127], v[64:79]
    ds_read_b64_tr_b16 a[0:1], v12 offset:32768
    ds_read_b64_tr_b16 a[2:3], v12 offset:34816
    ds_read_b64_tr_b16 a[4:5], v13 offset:32768
    ds_read_b64_tr_b16 a[6:7], v13 offset:34816
    s_waitcnt lgkmcnt(4)
    v_mfma_f32_32x32x16_bf16 v[80:95], a[24:27], v[124:127], v[80:95]
    ds_read_b64_tr_b16 a[8:9], v14 offset:32768
    ds_read_b64_tr_b16 a[10:11], v14 offset:34816
    v_mfma_f32_32x32x16_bf16 v[96:111], a[28:31], v[124:127], v[96:111]
    ds_read_b64_tr_b16 a[12:13], v15 offset:32768
    ds_read_b64_tr_b16 a[14:15], v15 offset:34816
    s_waitcnt lgkmcnt(4)
    v_mfma_f32_32x32x16_bf16 v[48:63], a[0:3], v[128:131], v[48:63]
    ds_read_b64_tr_b16 a[16:17], v12 offset:36864
    ds_read_b64_tr_b16 a[18:19], v12 offset:38912
    s_lshl_b32 s64, s57, 1
    s_add_u32 s64, s64, s54
    s_lshl_b32 s64, s64, 5
    v_mfma_f32_32x32x16_bf16 v[64:79], a[4:7], v[128:131], v[64:79]
    ds_read_b64_tr_b16 a[20:21], v13 offset:36864
    ds_read_b64_tr_b16 a[22:23], v13 offset:38912
    s_add_u32 s64, s64, s55
    s_lshl_b32 s64, s64, 2
    s_waitcnt lgkmcnt(4)
    v_mfma_f32_32x32x16_bf16 v[80:95], a[8:11], v[128:131], v[80:95]
    ds_read_b64_tr_b16 a[24:25], v14 offset:36864
    ds_read_b64_tr_b16 a[26:27], v14 offset:38912
    s_add_u32 s64, s64, 0xa14000
    s_waitcnt vmcnt(0)
    buffer_store_dword v30, off, s[36:39], s64 offset:0 sc1
    v_mfma_f32_32x32x16_bf16 v[96:111], a[12:15], v[128:131], v[96:111]
    ds_read_b64_tr_b16 a[28:29], v15 offset:36864
    ds_read_b64_tr_b16 a[30:31], v15 offset:38912
    s_waitcnt lgkmcnt(4)
    v_mfma_f32_32x32x16_bf16 v[48:63], a[16:19], v[132:135], v[48:63]
    ds_read_b64_tr_b16 a[0:1], v12 offset:40960
    ds_read_b64_tr_b16 a[2:3], v12 offset:43008
    v_mfma_f32_32x32x16_bf16 v[64:79], a[20:23], v[132:135], v[64:79]
    ds_read_b64_tr_b16 a[4:5], v13 offset:40960
    ds_read_b64_tr_b16 a[6:7], v13 offset:43008
    s_waitcnt lgkmcnt(4)
    v_mfma_f32_32x32x16_bf16 v[80:95], a[24:27], v[132:135], v[80:95]
    ds_read_b64_tr_b16 a[8:9], v14 offset:40960
    ds_read_b64_tr_b16 a[10:11], v14 offset:43008
    v_mfma_f32_32x32x16_bf16 v[96:111], a[28:31], v[132:135], v[96:111]
    ds_read_b64_tr_b16 a[12:13], v15 offset:40960
    ds_read_b64_tr_b16 a[14:15], v15 offset:43008
    s_waitcnt lgkmcnt(4)
    v_mfma_f32_32x32x16_bf16 v[48:63], a[0:3], v[136:139], v[48:63]
    ds_read_b64_tr_b16 a[16:17], v12 offset:45056
    ds_read_b64_tr_b16 a[18:19], v12 offset:47104
    s_mul_i32 s64, s69, 37
    s_lshr_b32 s64, s64, 8
    s_mul_i32 s65, s64, 7
    v_mfma_f32_32x32x16_bf16 v[64:79], a[4:7], v[136:139], v[64:79]
    ds_read_b64_tr_b16 a[20:21], v13 offset:45056
    ds_read_b64_tr_b16 a[22:23], v13 offset:47104
    s_sub_u32 s11, s69, s65
    s_lshl_b32 s15, s64, 1
    s_waitcnt lgkmcnt(4)
    v_mfma_f32_32x32x16_bf16 v[80:95], a[8:11], v[136:139], v[80:95]
    ds_read_b64_tr_b16 a[24:25], v14 offset:45056
    ds_read_b64_tr_b16 a[26:27], v14 offset:47104
    s_add_u32 s15, s15, s11
    s_cmp_ge_u32 s15, 7
    s_cselect_b32 s65, 7, 0
    v_mfma_f32_32x32x16_bf16 v[96:111], a[12:15], v[136:139], v[96:111]
    ds_read_b64_tr_b16 a[28:29], v15 offset:45056
    ds_read_b64_tr_b16 a[30:31], v15 offset:47104
    s_sub_u32 s15, s15, s65
    s_mov_b32 s71, s15
    s_and_b32 s4, s2, 7
    s_lshl_b32 s4, s4, 2
    s_waitcnt lgkmcnt(4)
    v_mfma_f32_32x32x16_bf16 v[48:63], a[16:19], v[140:143], v[48:63]
    s_barrier
    v_mfma_f32_32x32x16_bf16 v[64:79], a[20:23], v[140:143], v[64:79]
    ds_read_b64_tr_b16 a[0:1], v16 offset:0
    ds_read_b64_tr_b16 a[2:3], v16 offset:2048
    ds_read_b64_tr_b16 a[4:5], v17 offset:0
    ds_read_b64_tr_b16 a[6:7], v17 offset:2048
    s_waitcnt lgkmcnt(4)
    v_mfma_f32_32x32x16_bf16 v[80:95], a[24:27], v[140:143], v[80:95]
    ds_read_b64_tr_b16 a[8:9], v18 offset:0
    ds_read_b64_tr_b16 a[10:11], v18 offset:2048
    s_add_u32 s4, s4, s64
    s_and_b32 s3, s52, 1
    s_lshr_b32 s10, s52, 1
    v_mfma_f32_32x32x16_bf16 v[96:111], a[28:31], v[140:143], v[96:111]
    ds_read_b64_tr_b16 a[12:13], v19 offset:0
    ds_read_b64_tr_b16 a[14:15], v19 offset:2048
    s_lshl_b32 s4, s4, 1
    s_add_u32 s4, s4, s3
    s_waitcnt lgkmcnt(4)
    v_mfma_f32_32x32x16_bf16 v[48:63], a[0:3], v[144:147], v[48:63]
    ds_read_b64_tr_b16 a[16:17], v16 offset:4096
    ds_read_b64_tr_b16 a[18:19], v16 offset:6144
    s_lshl_b32 s69, s4, 1
    s_add_u32 s69, s69, s10
    s_lshl_b32 s69, s69, 7
    v_mfma_f32_32x32x16_bf16 v[64:79], a[4:7], v[144:147], v[64:79]
    ds_read_b64_tr_b16 a[20:21], v17 offset:4096
    ds_read_b64_tr_b16 a[22:23], v17 offset:6144
    s_add_u32 s69, s69, 0xa14000
    s_mov_b32 s48, s18
    s_waitcnt lgkmcnt(4)
    v_mfma_f32_32x32x16_bf16 v[80:95], a[8:11], v[144:147], v[80:95]
    ds_read_b64_tr_b16 a[24:25], v18 offset:4096
    ds_read_b64_tr_b16 a[26:27], v18 offset:6144
    s_mov_b32 s49, s19
    s_mov_b32 s50, 0x1c0000
    s_mov_b32 s51, 0x20000
    v_mfma_f32_32x32x16_bf16 v[96:111], a[12:15], v[144:147], v[96:111]
    ds_read_b64_tr_b16 a[28:29], v19 offset:4096
    ds_read_b64_tr_b16 a[30:31], v19 offset:6144
    s_mul_i32 s61, s4, 114688
    s_mul_i32 s64, s10, 57344
    s_add_u32 s61, s61, s64
    s_waitcnt lgkmcnt(4)
    v_mfma_f32_32x32x16_bf16 v[48:63], a[16:19], v[148:151], v[48:63]
    ds_read_b64_tr_b16 a[0:1], v16 offset:8192
    ds_read_b64_tr_b16 a[2:3], v16 offset:10240
    s_mul_i32 s62, s4, 28672
    s_lshl_b32 s64, s11, 7
    s_add_u32 s62, s62, s64
    v_mfma_f32_32x32x16_bf16 v[64:79], a[20:23], v[148:151], v[64:79]
    ds_read_b64_tr_b16 a[4:5], v17 offset:8192
    ds_read_b64_tr_b16 a[6:7], v17 offset:10240
    s_lshl_b32 s64, s10, 6
    s_add_u32 s62, s62, s64
    s_waitcnt lgkmcnt(4)
    v_mfma_f32_32x32x16_bf16 v[80:95], a[24:27], v[148:151], v[80:95]
    ds_read_b64_tr_b16 a[8:9], v18 offset:8192
    ds_read_b64_tr_b16 a[10:11], v18 offset:10240
    v_bfe_u32 v32, v0, 2, 2
    v_bfe_u32 v33, v0, 4, 1
    v_lshrrev_b32 v34, 5, v0
    v_mfma_f32_32x32x16_bf16 v[96:111], a[28:31], v[148:151], v[96:111]
    ds_read_b64_tr_b16 a[12:13], v19 offset:8192
    ds_read_b64_tr_b16 a[14:15], v19 offset:10240
    v_lshl_add_u32 v34, v34, 2, v32
    v_and_b32 v35, 3, v0
    v_lshlrev_b32 v35, 3, v35
    s_waitcnt lgkmcnt(4)
    v_mfma_f32_32x32x16_bf16 v[48:63], a[0:3], v[152:155], v[48:63]
    ds_read_b64_tr_b16 a[16:17], v16 offset:12288
    ds_read_b64_tr_b16 a[18:19], v16 offset:14336
    v_lshlrev_b32 v34, 7, v34
    v_lshl_add_u32 v34, v33, 5, v34
    v_add_u32 v34, v34, v35
    v_mfma_f32_32x32x16_bf16 v[64:79], a[4:7], v[152:155], v[64:79]
    ds_read_b64_tr_b16 a[20:21], v17 offset:12288
    ds_read_b64_tr_b16 a[22:23], v17 offset:14336
    v_lshrrev_b32 v32, 1, v32
    v_lshl_add_u32 v34, v32, 6, v34
    s_waitcnt lgkmcnt(4)
    v_mfma_f32_32x32x16_bf16 v[80:95], a[8:11], v[152:155], v[80:95]
    ds_read_b64_tr_b16 a[24:25], v18 offset:12288
    ds_read_b64_tr_b16 a[26:27], v18 offset:14336
    s_lshl_b32 s64, s10, 11
    v_add_u32 v6, s64, v34
    s_lshl_b32 s64, s10, 6
    v_mfma_f32_32x32x16_bf16 v[96:111], a[12:15], v[152:155], v[96:111]
    ds_read_b64_tr_b16 a[28:29], v19 offset:12288
    ds_read_b64_tr_b16 a[30:31], v19 offset:14336
    v_xor_b32 v6, s64, v6
    v_xor_b32 v7, 64, v6
    v_add_u32 v8, 0x10000, v6
    s_waitcnt lgkmcnt(4)
    v_mfma_f32_32x32x16_bf16 v[48:63], a[16:19], v[156:159], v[48:63]
    s_barrier
    v_mfma_f32_32x32x16_bf16 v[64:79], a[20:23], v[156:159], v[64:79]
    ds_read_b64_tr_b16 a[0:1], v16 offset:16384
    ds_read_b64_tr_b16 a[2:3], v16 offset:18432
    ds_read_b64_tr_b16 a[4:5], v17 offset:16384
    ds_read_b64_tr_b16 a[6:7], v17 offset:18432
    s_waitcnt lgkmcnt(4)
    v_mfma_f32_32x32x16_bf16 v[80:95], a[24:27], v[156:159], v[80:95]
    ds_read_b64_tr_b16 a[8:9], v18 offset:16384
    ds_read_b64_tr_b16 a[10:11], v18 offset:18432
    v_add_u32 v9, 0x10000, v7
    v_add_u32 v10, 0x20000, v6
    v_add_u32 v11, 0x20000, v7
    v_mfma_f32_32x32x16_bf16 v[96:111], a[28:31], v[156:159], v[96:111]
    ds_read_b64_tr_b16 a[12:13], v19 offset:16384
    ds_read_b64_tr_b16 a[14:15], v19 offset:18432
    s_waitcnt lgkmcnt(4)
    v_mfma_f32_32x32x16_bf16 v[48:63], a[0:3], v[160:163], v[48:63]
    ds_read_b64_tr_b16 a[16:17], v16 offset:20480
    ds_read_b64_tr_b16 a[18:19], v16 offset:22528
    v_mfma_f32_32x32x16_bf16 v[64:79], a[4:7], v[160:163], v[64:79]
    ds_read_b64_tr_b16 a[20:21], v17 offset:20480
    ds_read_b64_tr_b16 a[22:23], v17 offset:22528
    s_waitcnt lgkmcnt(4)
    v_mfma_f32_32x32x16_bf16 v[80:95], a[8:11], v[160:163], v[80:95]
    ds_read_b64_tr_b16 a[24:25], v18 offset:20480
    ds_read_b64_tr_b16 a[26:27], v18 offset:22528
    v_mfma_f32_32x32x16_bf16 v[96:111], a[12:15], v[160:163], v[96:111]
    ds_read_b64_tr_b16 a[28:29], v19 offset:20480
    ds_read_b64_tr_b16 a[30:31], v19 offset:22528
    s_waitcnt lgkmcnt(4)
    v_mfma_f32_32x32x16_bf16 v[48:63], a[16:19], v[164:167], v[48:63]
    ds_read_b64_tr_b16 a[0:1], v16 offset:24576
    ds_read_b64_tr_b16 a[2:3], v16 offset:26624
    v_mfma_f32_32x32x16_bf16 v[64:79], a[20:23], v[164:167], v[64:79]
    ds_read_b64_tr_b16 a[4:5], v17 offset:24576
    ds_read_b64_tr_b16 a[6:7], v17 offset:26624
    s_waitcnt lgkmcnt(4)
    v_mfma_f32_32x32x16_bf16 v[80:95], a[24:27], v[164:167], v[80:95]
    ds_read_b64_tr_b16 a[8:9], v18 offset:24576
    ds_read_b64_tr_b16 a[10:11], v18 offset:26624
    v_mfma_f32_32x32x16_bf16 v[96:111], a[28:31], v[164:167], v[96:111]
    ds_read_b64_tr_b16 a[12:13], v19 offset:24576
    ds_read_b64_tr_b16 a[14:15], v19 offset:26624
    s_waitcnt lgkmcnt(4)
    v_mfma_f32_32x32x16_bf16 v[48:63], a[0:3], v[168:171], v[48:63]
    ds_read_b64_tr_b16 a[16:17], v16 offset:28672
    ds_read_b64_tr_b16 a[18:19], v16 offset:30720
    v_mfma_f32_32x32x16_bf16 v[64:79], a[4:7], v[168:171], v[64:79]
    ds_read_b64_tr_b16 a[20:21], v17 offset:28672
    ds_read_b64_tr_b16 a[22:23], v17 offset:30720
    s_waitcnt lgkmcnt(4)
    v_mfma_f32_32x32x16_bf16 v[80:95], a[8:11], v[168:171], v[80:95]
    ds_read_b64_tr_b16 a[24:25], v18 offset:28672
    ds_read_b64_tr_b16 a[26:27], v18 offset:30720
    v_mfma_f32_32x32x16_bf16 v[96:111], a[12:15], v[168:171], v[96:111]
    ds_read_b64_tr_b16 a[28:29], v19 offset:28672
    ds_read_b64_tr_b16 a[30:31], v19 offset:30720
    s_waitcnt lgkmcnt(4)
    v_mfma_f32_32x32x16_bf16 v[48:63], a[16:19], v[172:175], v[48:63]
    s_barrier
    v_mfma_f32_32x32x16_bf16 v[64:79], a[20:23], v[172:175], v[64:79]
    ds_read_b64_tr_b16 a[0:1], v16 offset:32768
    ds_read_b64_tr_b16 a[2:3], v16 offset:34816
    ds_read_b64_tr_b16 a[4:5], v17 offset:32768
    ds_read_b64_tr_b16 a[6:7], v17 offset:34816
    s_waitcnt lgkmcnt(4)
    v_mfma_f32_32x32x16_bf16 v[80:95], a[24:27], v[172:175], v[80:95]
    ds_read_b64_tr_b16 a[8:9], v18 offset:32768
    ds_read_b64_tr_b16 a[10:11], v18 offset:34816
    v_mfma_f32_32x32x16_bf16 v[96:111], a[28:31], v[172:175], v[96:111]
    ds_read_b64_tr_b16 a[12:13], v19 offset:32768
    ds_read_b64_tr_b16 a[14:15], v19 offset:34816
    s_waitcnt lgkmcnt(4)
    v_mfma_f32_32x32x16_bf16 v[48:63], a[0:3], v[176:179], v[48:63]
    ds_read_b64_tr_b16 a[16:17], v16 offset:36864
    ds_read_b64_tr_b16 a[18:19], v16 offset:38912
    v_mfma_f32_32x32x16_bf16 v[64:79], a[4:7], v[176:179], v[64:79]
    ds_read_b64_tr_b16 a[20:21], v17 offset:36864
    ds_read_b64_tr_b16 a[22:23], v17 offset:38912
    s_waitcnt lgkmcnt(4)
    v_mfma_f32_32x32x16_bf16 v[80:95], a[8:11], v[176:179], v[80:95]
    ds_read_b64_tr_b16 a[24:25], v18 offset:36864
    ds_read_b64_tr_b16 a[26:27], v18 offset:38912
    v_mfma_f32_32x32x16_bf16 v[96:111], a[12:15], v[176:179], v[96:111]
    ds_read_b64_tr_b16 a[28:29], v19 offset:36864
    ds_read_b64_tr_b16 a[30:31], v19 offset:38912
    s_waitcnt lgkmcnt(4)
    v_mfma_f32_32x32x16_bf16 v[48:63], a[16:19], v[180:183], v[48:63]
    ds_read_b64_tr_b16 a[0:1], v16 offset:40960
    ds_read_b64_tr_b16 a[2:3], v16 offset:43008
    v_mfma_f32_32x32x16_bf16 v[64:79], a[20:23], v[180:183], v[64:79]
    ds_read_b64_tr_b16 a[4:5], v17 offset:40960
    ds_read_b64_tr_b16 a[6:7], v17 offset:43008
    s_waitcnt lgkmcnt(4)
    v_mfma_f32_32x32x16_bf16 v[80:95], a[24:27], v[180:183], v[80:95]
    ds_read_b64_tr_b16 a[8:9], v18 offset:40960
    ds_read_b64_tr_b16 a[10:11], v18 offset:43008
    v_mfma_f32_32x32x16_bf16 v[96:111], a[28:31], v[180:183], v[96:111]
    ds_read_b64_tr_b16 a[12:13], v19 offset:40960
    ds_read_b64_tr_b16 a[14:15], v19 offset:43008
    s_waitcnt lgkmcnt(4)
    v_mfma_f32_32x32x16_bf16 v[48:63], a[0:3], v[184:187], v[48:63]
    ds_read_b64_tr_b16 a[16:17], v16 offset:45056
    ds_read_b64_tr_b16 a[18:19], v16 offset:47104
    v_mfma_f32_32x32x16_bf16 v[64:79], a[4:7], v[184:187], v[64:79]
    ds_read_b64_tr_b16 a[20:21], v17 offset:45056
    ds_read_b64_tr_b16 a[22:23], v17 offset:47104
    s_waitcnt lgkmcnt(4)
    v_mfma_f32_32x32x16_bf16 v[80:95], a[8:11], v[184:187], v[80:95]
    ds_read_b64_tr_b16 a[24:25], v18 offset:45056
    ds_read_b64_tr_b16 a[26:27], v18 offset:47104
    v_mfma_f32_32x32x16_bf16 v[96:111], a[12:15], v[184:187], v[96:111]
    ds_read_b64_tr_b16 a[28:29], v19 offset:45056
    ds_read_b64_tr_b16 a[30:31], v19 offset:47104
    s_waitcnt lgkmcnt(4)
    v_mfma_f32_32x32x16_bf16 v[48:63], a[16:19], v[188:191], v[48:63]
    s_barrier
    v_mfma_f32_32x32x16_bf16 v[64:79], a[20:23], v[188:191], v[64:79]
    ds_read_b64_tr_b16 a[0:1], v16 offset:49152
    ds_read_b64_tr_b16 a[2:3], v16 offset:51200
    ds_read_b64_tr_b16 a[4:5], v17 offset:49152
    ds_read_b64_tr_b16 a[6:7], v17 offset:51200
    s_waitcnt lgkmcnt(4)
    v_mfma_f32_32x32x16_bf16 v[80:95], a[24:27], v[188:191], v[80:95]
    ds_read_b64_tr_b16 a[8:9], v18 offset:49152
    ds_read_b64_tr_b16 a[10:11], v18 offset:51200
    v_mfma_f32_32x32x16_bf16 v[96:111], a[28:31], v[188:191], v[96:111]
    ds_read_b64_tr_b16 a[12:13], v19 offset:49152
    ds_read_b64_tr_b16 a[14:15], v19 offset:51200
    s_waitcnt lgkmcnt(4)
    v_mfma_f32_32x32x16_bf16 v[48:63], a[0:3], v[192:195], v[48:63]
    ds_read_b64_tr_b16 a[16:17], v16 offset:53248
    ds_read_b64_tr_b16 a[18:19], v16 offset:55296
    v_mfma_f32_32x32x16_bf16 v[64:79], a[4:7], v[192:195], v[64:79]
    ds_read_b64_tr_b16 a[20:21], v17 offset:53248
    ds_read_b64_tr_b16 a[22:23], v17 offset:55296
    s_waitcnt lgkmcnt(4)
    v_mfma_f32_32x32x16_bf16 v[80:95], a[8:11], v[192:195], v[80:95]
    ds_read_b64_tr_b16 a[24:25], v18 offset:53248
    ds_read_b64_tr_b16 a[26:27], v18 offset:55296
    v_mfma_f32_32x32x16_bf16 v[96:111], a[12:15], v[192:195], v[96:111]
    ds_read_b64_tr_b16 a[28:29], v19 offset:53248
    ds_read_b64_tr_b16 a[30:31], v19 offset:55296
    s_waitcnt lgkmcnt(4)
    v_mfma_f32_32x32x16_bf16 v[48:63], a[16:19], v[196:199], v[48:63]
    ds_read_b64_tr_b16 a[0:1], v16 offset:57344
    ds_read_b64_tr_b16 a[2:3], v16 offset:59392
    v_mfma_f32_32x32x16_bf16 v[64:79], a[20:23], v[196:199], v[64:79]
    ds_read_b64_tr_b16 a[4:5], v17 offset:57344
    ds_read_b64_tr_b16 a[6:7], v17 offset:59392
    s_waitcnt lgkmcnt(4)
    v_mfma_f32_32x32x16_bf16 v[80:95], a[24:27], v[196:199], v[80:95]
    ds_read_b64_tr_b16 a[8:9], v18 offset:57344
    ds_read_b64_tr_b16 a[10:11], v18 offset:59392
    v_mfma_f32_32x32x16_bf16 v[96:111], a[28:31], v[196:199], v[96:111]
    ds_read_b64_tr_b16 a[12:13], v19 offset:57344
    ds_read_b64_tr_b16 a[14:15], v19 offset:59392
    s_waitcnt lgkmcnt(4)
    v_mfma_f32_32x32x16_bf16 v[48:63], a[0:3], v[200:203], v[48:63]
    ds_read_b64_tr_b16 a[16:17], v16 offset:61440
    ds_read_b64_tr_b16 a[18:19], v16 offset:63488
    v_and_b32 v31, 7, v0
    v_min_u32 v31, 6, v31
    v_lshlrev_b32 v31, 2, v31
    v_mfma_f32_32x32x16_bf16 v[64:79], a[4:7], v[200:203], v[64:79]
    ds_read_b64_tr_b16 a[20:21], v17 offset:61440
    ds_read_b64_tr_b16 a[22:23], v17 offset:63488
    buffer_load_dword v2, v31, s[36:39], s69 offen offset:0 sc1
    s_waitcnt lgkmcnt(4)
    v_mfma_f32_32x32x16_bf16 v[80:95], a[8:11], v[200:203], v[80:95]
    ds_read_b64_tr_b16 a[24:25], v18 offset:61440
    ds_read_b64_tr_b16 a[26:27], v18 offset:63488
    v_mfma_f32_32x32x16_bf16 v[96:111], a[12:15], v[200:203], v[96:111]
    ds_read_b64_tr_b16 a[28:29], v19 offset:61440
    ds_read_b64_tr_b16 a[30:31], v19 offset:63488
    s_waitcnt lgkmcnt(4)
    v_mfma_f32_32x32x16_bf16 v[48:63], a[16:19], v[204:207], v[48:63]
    s_barrier
    v_mfma_f32_32x32x16_bf16 v[64:79], a[20:23], v[204:207], v[64:79]
    ds_read_b64_tr_b16 a[0:1], v20 offset:0
    ds_read_b64_tr_b16 a[2:3], v20 offset:2048
    ds_read_b64_tr_b16 a[4:5], v21 offset:0
    ds_read_b64_tr_b16 a[6:7], v21 offset:2048
    s_waitcnt lgkmcnt(4)
    v_mfma_f32_32x32x16_bf16 v[80:95], a[24:27], v[204:207], v[80:95]
    ds_read_b64_tr_b16 a[8:9], v22 offset:0
    ds_read_b64_tr_b16 a[10:11], v22 offset:2048
    v_mfma_f32_32x32x16_bf16 v[96:111], a[28:31], v[204:207], v[96:111]
    ds_read_b64_tr_b16 a[12:13], v23 offset:0
    ds_read_b64_tr_b16 a[14:15], v23 offset:2048
    s_waitcnt lgkmcnt(4)
    v_mfma_f32_32x32x16_bf16 v[48:63], a[0:3], v[208:211], v[48:63]
    ds_read_b64_tr_b16 a[16:17], v20 offset:4096
    ds_read_b64_tr_b16 a[18:19], v20 offset:6144
    v_mfma_f32_32x32x16_bf16 v[64:79], a[4:7], v[208:211], v[64:79]
    ds_read_b64_tr_b16 a[20:21], v21 offset:4096
    ds_read_b64_tr_b16 a[22:23], v21 offset:6144
    s_waitcnt lgkmcnt(4)
    v_mfma_f32_32x32x16_bf16 v[80:95], a[8:11], v[208:211], v[80:95]
    ds_read_b64_tr_b16 a[24:25], v22 offset:4096
    ds_read_b64_tr_b16 a[26:27], v22 offset:6144
    v_mfma_f32_32x32x16_bf16 v[96:111], a[12:15], v[208:211], v[96:111]
    ds_read_b64_tr_b16 a[28:29], v23 offset:4096
    ds_read_b64_tr_b16 a[30:31], v23 offset:6144
    s_waitcnt lgkmcnt(4)
    v_mfma_f32_32x32x16_bf16 v[48:63], a[16:19], v[212:215], v[48:63]
    ds_read_b64_tr_b16 a[0:1], v20 offset:8192
    ds_read_b64_tr_b16 a[2:3], v20 offset:10240
    v_mfma_f32_32x32x16_bf16 v[64:79], a[20:23], v[212:215], v[64:79]
    ds_read_b64_tr_b16 a[4:5], v21 offset:8192
    ds_read_b64_tr_b16 a[6:7], v21 offset:10240
    s_waitcnt lgkmcnt(4)
    v_mfma_f32_32x32x16_bf16 v[80:95], a[24:27], v[212:215], v[80:95]
    ds_read_b64_tr_b16 a[8:9], v22 offset:8192
    ds_read_b64_tr_b16 a[10:11], v22 offset:10240
    v_mfma_f32_32x32x16_bf16 v[96:111], a[28:31], v[212:215], v[96:111]
    ds_read_b64_tr_b16 a[12:13], v23 offset:8192
    ds_read_b64_tr_b16 a[14:15], v23 offset:10240
    s_waitcnt lgkmcnt(4)
    v_mfma_f32_32x32x16_bf16 v[48:63], a[0:3], v[216:219], v[48:63]
    ds_read_b64_tr_b16 a[16:17], v20 offset:12288
    ds_read_b64_tr_b16 a[18:19], v20 offset:14336
    v_mfma_f32_32x32x16_bf16 v[64:79], a[4:7], v[216:219], v[64:79]
    ds_read_b64_tr_b16 a[20:21], v21 offset:12288
    ds_read_b64_tr_b16 a[22:23], v21 offset:14336
    s_waitcnt lgkmcnt(4)
    v_mfma_f32_32x32x16_bf16 v[80:95], a[8:11], v[216:219], v[80:95]
    ds_read_b64_tr_b16 a[24:25], v22 offset:12288
    ds_read_b64_tr_b16 a[26:27], v22 offset:14336
    v_mfma_f32_32x32x16_bf16 v[96:111], a[12:15], v[216:219], v[96:111]
    ds_read_b64_tr_b16 a[28:29], v23 offset:12288
    ds_read_b64_tr_b16 a[30:31], v23 offset:14336
    s_waitcnt lgkmcnt(4)
    v_mfma_f32_32x32x16_bf16 v[48:63], a[16:19], v[220:223], v[48:63]
    v_mfma_f32_32x32x16_bf16 v[64:79], a[20:23], v[220:223], v[64:79]
    s_waitcnt lgkmcnt(0)
    v_mfma_f32_32x32x16_bf16 v[80:95], a[24:27], v[220:223], v[80:95]
    v_mfma_f32_32x32x16_bf16 v[96:111], a[28:31], v[220:223], v[96:111]
    v_and_b32 v32, 31, v0
    v_mul_u32_u24 v12, 896, v32
    v_lshrrev_b32 v33, 5, v0
    v_lshl_add_u32 v12, v33, 3, v12
    s_lshl_b32 s64, s52, 12
    v_add_u32 v13, s64, v1
    s_xor_b32 s64, s52, 2
    s_lshl_b32 s64, s64, 12
    v_add_u32 v14, s64, v1
    s_mul_i32 s66, s57, 114688
    s_mul_i32 s64, s54, 57344
    s_add_u32 s66, s66, s64
    s_lshl_b32 s64, s55, 12
    s_add_u32 s66, s66, s64
    s_add_u32 s66, s66, 28672
    v_mul_f32 v32, v48, v24
    v_mul_f32 v33, v49, v24
    v_mul_f32 v34, v50, v24
    v_mul_f32 v35, v51, v24
    v_mul_f32 v36, v52, v24
    v_mul_f32 v37, v53, v24
    v_mul_f32 v38, v54, v24
    v_mul_f32 v39, v55, v24
    v_exp_f32 v32, v32
    v_mul_f32 v48, v48, v56
    v_exp_f32 v33, v33
    v_mul_f32 v49, v49, v57
    v_exp_f32 v34, v34
    v_mul_f32 v50, v50, v58
    v_exp_f32 v35, v35
    v_mul_f32 v51, v51, v59
    v_exp_f32 v36, v36
    v_mul_f32 v52, v52, v60
    v_exp_f32 v37, v37
    v_mul_f32 v53, v53, v61
    v_exp_f32 v38, v38
    v_mul_f32 v54, v54, v62
    v_exp_f32 v39, v39
    v_mul_f32 v55, v55, v63
    v_fma_f32 v32, v32, v25, v25
    v_fma_f32 v33, v33, v25, v25
    v_fma_f32 v34, v34, v25, v25
    v_fma_f32 v35, v35, v25, v25
    v_fma_f32 v36, v36, v25, v25
    v_fma_f32 v37, v37, v25, v25
    v_fma_f32 v38, v38, v25, v25
    v_fma_f32 v39, v39, v25, v25
    v_rcp_f32 v32, v32
    v_rcp_f32 v33, v33
    v_rcp_f32 v34, v34
    v_rcp_f32 v35, v35
    v_rcp_f32 v36, v36
    v_rcp_f32 v37, v37
    v_rcp_f32 v38, v38
    v_rcp_f32 v39, v39
    v_mul_f32 v48, v48, v32
    v_mul_f32 v49, v49, v33
    v_mul_f32 v50, v50, v34
    v_mul_f32 v51, v51, v35
    v_mul_f32 v52, v52, v36
    v_mul_f32 v53, v53, v37
    v_mul_f32 v54, v54, v38
    v_mul_f32 v55, v55, v39
    v_cvt_pk_bf16_f32 v40, v48, v49
    v_cvt_pk_bf16_f32 v41, v50, v51
    v_cvt_pk_bf16_f32 v42, v52, v53
    v_cvt_pk_bf16_f32 v43, v54, v55
    buffer_store_dwordx4 v[40:43], v1, s[36:39], s66 offen offset:0 sc1
    v_mul_f32 v32, v64, v24
    v_mul_f32 v33, v65, v24
    v_mul_f32 v34, v66, v24
    v_mul_f32 v35, v67, v24
    v_mul_f32 v36, v68, v24
    v_mul_f32 v37, v69, v24
    v_mul_f32 v38, v70, v24
    v_mul_f32 v39, v71, v24
    v_exp_f32 v32, v32
    v_mul_f32 v64, v64, v72
    v_exp_f32 v33, v33
    v_mul_f32 v65, v65, v73
    v_exp_f32 v34, v34
    v_mul_f32 v66, v66, v74
    v_exp_f32 v35, v35
    v_mul_f32 v67, v67, v75
    v_exp_f32 v36, v36
    v_mul_f32 v68, v68, v76
    v_exp_f32 v37, v37
    v_mul_f32 v69, v69, v77
    v_exp_f32 v38, v38
    v_mul_f32 v70, v70, v78
    v_exp_f32 v39, v39
    v_mul_f32 v71, v71, v79
    v_fma_f32 v32, v32, v25, v25
    v_fma_f32 v33, v33, v25, v25
    v_fma_f32 v34, v34, v25, v25
    v_fma_f32 v35, v35, v25, v25
    v_fma_f32 v36, v36, v25, v25
    v_fma_f32 v37, v37, v25, v25
    v_fma_f32 v38, v38, v25, v25
    v_fma_f32 v39, v39, v25, v25
    v_rcp_f32 v32, v32
    v_rcp_f32 v33, v33
    v_rcp_f32 v34, v34
    v_rcp_f32 v35, v35
    v_rcp_f32 v36, v36
    v_rcp_f32 v37, v37
    v_rcp_f32 v38, v38
    v_rcp_f32 v39, v39
    v_mul_f32 v64, v64, v32
    v_mul_f32 v65, v65, v33
    v_mul_f32 v66, v66, v34
    v_mul_f32 v67, v67, v35
    v_mul_f32 v68, v68, v36
    v_mul_f32 v69, v69, v37
    v_mul_f32 v70, v70, v38
    v_mul_f32 v71, v71, v39
    v_cvt_pk_bf16_f32 v44, v64, v65
    v_cvt_pk_bf16_f32 v45, v66, v67
    v_cvt_pk_bf16_f32 v46, v68, v69
    v_cvt_pk_bf16_f32 v47, v70, v71
    buffer_store_dwordx4 v[44:47], v1, s[36:39], s66 offen offset:1024 sc1
    v_mul_f32 v32, v80, v24
    v_mul_f32 v33, v81, v24
    v_mul_f32 v34, v82, v24
    v_mul_f32 v35, v83, v24
    v_mul_f32 v36, v84, v24
    v_mul_f32 v37, v85, v24
    v_mul_f32 v38, v86, v24
    v_mul_f32 v39, v87, v24
    s_waitcnt vmcnt(2)
    v_cmp_ne_u32 vcc, s67, v2
    s_cbranch_vccnz LS_h0
LB_h0:
    s_nop 4
    v_exp_f32 v32, v32
    v_mul_f32 v80, v80, v88
    v_exp_f32 v33, v33
    v_mul_f32 v81, v81, v89
    v_exp_f32 v34, v34
    v_mul_f32 v82, v82, v90
    v_exp_f32 v35, v35
    v_mul_f32 v83, v83, v91
    v_exp_f32 v36, v36
    v_mul_f32 v84, v84, v92
    v_exp_f32 v37, v37
    v_mul_f32 v85, v85, v93
    v_exp_f32 v38, v38
    v_mul_f32 v86, v86, v94
    v_exp_f32 v39, v39
    v_mul_f32 v87, v87, v95
    v_fma_f32 v32, v32, v25, v25
    v_fma_f32 v33, v33, v25, v25
    v_fma_f32 v34, v34, v25, v25
    v_fma_f32 v35, v35, v25, v25
    v_fma_f32 v36, v36, v25, v25
    v_fma_f32 v37, v37, v25, v25
    v_fma_f32 v38, v38, v25, v25
    v_fma_f32 v39, v39, v25, v25
    v_rcp_f32 v32, v32
    v_rcp_f32 v33, v33
    v_rcp_f32 v34, v34
    v_rcp_f32 v35, v35
    v_rcp_f32 v36, v36
    v_rcp_f32 v37, v37
    v_rcp_f32 v38, v38
    v_rcp_f32 v39, v39
    v_mul_f32 v80, v80, v32
    v_mul_f32 v81, v81, v33
    v_mul_f32 v82, v82, v34
    v_mul_f32 v83, v83, v35
    v_mul_f32 v84, v84, v36
    v_mul_f32 v85, v85, v37
    v_mul_f32 v86, v86, v38
    v_mul_f32 v87, v87, v39
    v_cvt_pk_bf16_f32 v40, v80, v81
    v_cvt_pk_bf16_f32 v41, v82, v83
    v_cvt_pk_bf16_f32 v42, v84, v85
    v_cvt_pk_bf16_f32 v43, v86, v87
    buffer_store_dwordx4 v[40:43], v1, s[36:39], s66 offen offset:2048 sc1
    v_mul_f32 v32, v96, v24
    v_mul_f32 v33, v97, v24
    v_mul_f32 v34, v98, v24
    v_mul_f32 v35, v99, v24
    v_mul_f32 v36, v100, v24
    v_mul_f32 v37, v101, v24
    v_mul_f32 v38, v102, v24
    v_mul_f32 v39, v103, v24
    v_exp_f32 v32, v32
    v_mul_f32 v96, v96, v104
    v_exp_f32 v33, v33
    v_mul_f32 v97, v97, v105
    v_exp_f32 v34, v34
    v_mul_f32 v98, v98, v106
    v_exp_f32 v35, v35
    v_mul_f32 v99, v99, v107
    v_exp_f32 v36, v36
    v_mul_f32 v100, v100, v108
    v_exp_f32 v37, v37
    v_mul_f32 v101, v101, v109
    v_exp_f32 v38, v38
    v_mul_f32 v102, v102, v110
    v_exp_f32 v39, v39
    v_mul_f32 v103, v103, v111
    v_fma_f32 v32, v32, v25, v25
    v_fma_f32 v33, v33, v25, v25
    v_fma_f32 v34, v34, v25, v25
    v_fma_f32 v35, v35, v25, v25
    v_fma_f32 v36, v36, v25, v25
    v_fma_f32 v37, v37, v25, v25
    v_fma_f32 v38, v38, v25, v25
    v_fma_f32 v39, v39, v25, v25
    v_rcp_f32 v32, v32
    v_rcp_f32 v33, v33
    v_rcp_f32 v34, v34
    v_rcp_f32 v35, v35
    v_rcp_f32 v36, v36
    v_rcp_f32 v37, v37
    v_rcp_f32 v38, v38
    v_rcp_f32 v39, v39
    v_mul_f32 v96, v96, v32
    v_mul_f32 v97, v97, v33
    v_mul_f32 v98, v98, v34
    v_mul_f32 v99, v99, v35
    v_mul_f32 v100, v100, v36
    v_mul_f32 v101, v101, v37
    v_mul_f32 v102, v102, v38
    v_mul_f32 v103, v103, v39
    v_cvt_pk_bf16_f32 v44, v96, v97
    v_cvt_pk_bf16_f32 v45, v98, v99
    v_cvt_pk_bf16_f32 v46, v100, v101
    v_cvt_pk_bf16_f32 v47, v102, v103
    buffer_store_dwordx4 v[44:47], v1, s[36:39], s66 offen offset:3072 sc1
    s_lshl_b32 s6, s71, 12
    s_add_u32 s6, s6, s61
    s_add_u32 s71, s71, 1
    s_cmp_eq_u32 s71, 7
    s_cselect_b32 s71, 0, s71
    buffer_load_dwordx4 v[112:115], v1, s[36:39], s6 offen offset:0 sc1
    buffer_load_dwordx4 v[116:119], v1, s[36:39], s6 offen offset:1024 sc1
    buffer_load_dwordx4 v[120:123], v1, s[36:39], s6 offen offset:2048 sc1
    buffer_load_dwordx4 v[124:127], v1, s[36:39], s6 offen offset:3072 sc1
    s_lshl_b32 s6, s71, 12
    s_add_u32 s6, s6, s61
    s_add_u32 s71, s71, 1
    s_cmp_eq_u32 s71, 7
    s_cselect_b32 s71, 0, s71
    buffer_load_dwordx4 v[128:131], v1, s[36:39], s6 offen offset:0 sc1
    buffer_load_dwordx4 v[132:135], v1, s[36:39], s6 offen offset:1024 sc1
    buffer_load_dwordx4 v[136:139], v1, s[36:39], s6 offen offset:2048 sc1
    buffer_load_dwordx4 v[140:143], v1, s[36:39], s6 offen offset:3072 sc1
    s_lshl_b32 s6, s71, 12
    s_add_u32 s6, s6, s61
    s_add_u32 s71, s71, 1
    s_cmp_eq_u32 s71, 7
    s_cselect_b32 s71, 0, s71
    buffer_load_dwordx4 v[144:147], v1, s[36:39], s6 offen offset:0 sc1
    buffer_load_dwordx4 v[148:151], v1, s[36:39], s6 offen offset:1024 sc1
    s_barrier
    ds_read_b64_tr_b16 a[0:1], v10 offset:16384
    ds_read_b64_tr_b16 a[2:3], v10 offset:17408
    ds_read_b64_tr_b16 a[4:5], v11 offset:16384
    ds_read_b64_tr_b16 a[6:7], v11 offset:17408
    ds_read_b64_tr_b16 a[8:9], v10 offset:20480
    ds_read_b64_tr_b16 a[10:11], v10 offset:21504
    ds_read_b64_tr_b16 a[12:13], v11 offset:20480
    ds_read_b64_tr_b16 a[14:15], v11 offset:21504
    s_waitcnt vmcnt(9) lgkmcnt(4)
    s_lshl_b32 s64, s57, 1
    s_add_u32 s64, s64, s54
    s_lshl_b32 s64, s64, 5
    s_add_u32 s64, s64, s55
    s_lshl_b32 s64, s64, 2
    s_add_u32 s64, s64, 0xa14020
    buffer_store_dword v30, off, s[36:39], s64 offset:0 sc1
    v_mfma_f32_32x32x16_bf16 v[48:63], a[0:3], v[112:115], 0
    ds_read_b64_tr_b16 a[16:17], v10 offset:24576
    ds_read_b64_tr_b16 a[18:19], v10 offset:25600
    ds_read_b64_tr_b16 a[20:21], v11 offset:24576
    ds_read_b64_tr_b16 a[22:23], v11 offset:25600
    v_mfma_f32_32x32x16_bf16 v[64:79], a[4:7], v[112:115], 0
    buffer_load_dwordx4 v[152:155], v1, s[36:39], s6 offen offset:2048 sc1
    s_waitcnt vmcnt(10) lgkmcnt(4)
    v_mfma_f32_32x32x16_bf16 v[48:63], a[8:11], v[116:119], v[48:63]
    ds_read_b64_tr_b16 a[0:1], v10 offset:28672
    ds_read_b64_tr_b16 a[2:3], v10 offset:29696
    ds_read_b64_tr_b16 a[4:5], v11 offset:28672
    ds_read_b64_tr_b16 a[6:7], v11 offset:29696
    v_mfma_f32_32x32x16_bf16 v[64:79], a[12:15], v[116:119], v[64:79]
    buffer_load_dwordx4 v[156:159], v1, s[36:39], s6 offen offset:3072 sc1
    s_barrier
    s_waitcnt vmcnt(10) lgkmcnt(4)
    v_mfma_f32_32x32x16_bf16 v[48:63], a[16:19], v[120:123], v[48:63]
    ds_read_b64_tr_b16 a[8:9], v6 offset:0
    ds_read_b64_tr_b16 a[10:11], v6 offset:1024
    ds_read_b64_tr_b16 a[12:13], v7 offset:0
    ds_read_b64_tr_b16 a[14:15], v7 offset:1024
    v_mfma_f32_32x32x16_bf16 v[64:79], a[20:23], v[120:123], v[64:79]
    s_lshl_b32 s6, s71, 12
    s_add_u32 s6, s6, s61
    s_add_u32 s71, s71, 1
    s_cmp_eq_u32 s71, 7
    s_cselect_b32 s71, 0, s71
    buffer_load_dwordx4 v[160:163], v1, s[36:39], s6 offen offset:0 sc1
    s_waitcnt vmcnt(10) lgkmcnt(4)
    v_mfma_f32_32x32x16_bf16 v[48:63], a[0:3], v[124:127], v[48:63]
    ds_read_b64_tr_b16 a[16:17], v6 offset:4096
    ds_read_b64_tr_b16 a[18:19], v6 offset:5120
    ds_read_b64_tr_b16 a[20:21], v7 offset:4096
    ds_read_b64_tr_b16 a[22:23], v7 offset:5120
    v_mfma_f32_32x32x16_bf16 v[64:79], a[4:7], v[124:127], v[64:79]
    buffer_load_dwordx4 v[164:167], v1, s[36:39], s6 offen offset:1024 sc1
    s_waitcnt vmcnt(10) lgkmcnt(4)
    v_mfma_f32_32x32x16_bf16 v[48:63], a[8:11], v[128:131], v[48:63]
    ds_read_b64_tr_b16 a[0:1], v6 offset:8192
    ds_read_b64_tr_b16 a[2:3], v6 offset:9216
    ds_read_b64_tr_b16 a[4:5], v7 offset:8192
    ds_read_b64_tr_b16 a[6:7], v7 offset:9216
    v_mfma_f32_32x32x16_bf16 v[64:79], a[12:15], v[128:131], v[64:79]
    buffer_load_dwordx4 v[168:171], v1, s[36:39], s6 offen offset:2048 sc1
    buffer_load_dwordx2 v[96:97], v12, s[24:27], s62 offen offset:0
    buffer_load_dwordx2 v[98:99], v12, s[24:27], s62 offen offset:16
    buffer_load_dwordx2 v[100:101], v12, s[24:27], s62 offen offset:32
    buffer_load_dwordx2 v[102:103], v12, s[24:27], s62 offen offset:48
    s_waitcnt vmcnt(14) lgkmcnt(4)
    v_mfma_f32_32x32x16_bf16 v[48:63], a[16:19], v[132:135], v[48:63]
    ds_read_b64_tr_b16 a[8:9], v6 offset:12288
    ds_read_b64_tr_b16 a[10:11], v6 offset:13312
    ds_read_b64_tr_b16 a[12:13], v7 offset:12288
    ds_read_b64_tr_b16 a[14:15], v7 offset:13312
    v_mfma_f32_32x32x16_bf16 v[64:79], a[20:23], v[132:135], v[64:79]
    buffer_load_dwordx4 v[172:175], v1, s[36:39], s6 offen offset:3072 sc1
    s_barrier
    s_waitcnt vmcnt(14) lgkmcnt(4)
    v_mfma_f32_32x32x16_bf16 v[48:63], a[0:3], v[136:139], v[48:63]
    ds_read_b64_tr_b16 a[16:17], v6 offset:32768
    ds_read_b64_tr_b16 a[18:19], v6 offset:33792
    ds_read_b64_tr_b16 a[20:21], v7 offset:32768
    ds_read_b64_tr_b16 a[22:23], v7 offset:33792
    v_mfma_f32_32x32x16_bf16 v[64:79], a[4:7], v[136:139], v[64:79]
    s_lshl_b32 s6, s71, 12
    s_add_u32 s6, s6, s61
    s_add_u32 s71, s71, 1
    s_cmp_eq_u32 s71, 7
    s_cselect_b32 s71, 0, s71
    buffer_load_dwordx4 v[176:179], v1, s[36:39], s6 offen offset:0 sc1
    s_waitcnt vmcnt(14) lgkmcnt(4)
    v_mfma_f32_32x32x16_bf16 v[48:63], a[8:11], v[140:143], v[48:63]
    ds_read_b64_tr_b16 a[0:1], v6 offset:36864
    ds_read_b64_tr_b16 a[2:3], v6 offset:37888
    ds_read_b64_tr_b16 a[4:5], v7 offset:36864
    ds_read_b64_tr_b16 a[6:7], v7 offset:37888
    v_mfma_f32_32x32x16_bf16 v[64:79], a[12:15], v[140:143], v[64:79]
    buffer_load_dwordx4 v[180:183], v1, s[36:39], s6 offen offset:1024 sc1
    s_waitcnt vmcnt(14) lgkmcnt(4)
    v_mfma_f32_32x32x16_bf16 v[48:63], a[16:19], v[144:147], v[48:63]
    ds_read_b64_tr_b16 a[8:9], v6 offset:40960
    ds_read_b64_tr_b16 a[10:11], v6 offset:41984
    ds_read_b64_tr_b16 a[12:13], v7 offset:40960
    ds_read_b64_tr_b16 a[14:15], v7 offset:41984
    v_mfma_f32_32x32x16_bf16 v[64:79], a[20:23], v[144:147], v[64:79]
    buffer_load_dwordx4 v[184:187], v1, s[36:39], s6 offen offset:2048 sc1
    s_waitcnt vmcnt(14) lgkmcnt(4)
    v_mfma_f32_32x32x16_bf16 v[48:63], a[0:3], v[148:151], v[48:63]
    ds_read_b64_tr_b16 a[16:17], v6 offset:45056
    ds_read_b64_tr_b16 a[18:19], v6 offset:46080
    ds_read_b64_tr_b16 a[20:21], v7 offset:45056
    ds_read_b64_tr_b16 a[22:23], v7 offset:46080
    v_mfma_f32_32x32x16_bf16 v[64:79], a[4:7], v[148:151], v[64:79]
    buffer_load_dwordx4 v[188:191], v1, s[36:39], s6 offen offset:3072 sc1
    s_barrier
    s_waitcnt vmcnt(13) lgkmcnt(4)
    v_mfma_f32_32x32x16_bf16 v[48:63], a[8:11], v[152:155], v[48:63]
    ds_read_b64_tr_b16 a[0:1], v8 offset:0
    ds_read_b64_tr_b16 a[2:3], v8 offset:1024
    ds_read_b64_tr_b16 a[4:5], v9 offset:0
    ds_read_b64_tr_b16 a[6:7], v9 offset:1024
    v_mfma_f32_32x32x16_bf16 v[64:79], a[12:15], v[152:155], v[64:79]
    s_lshl_b32 s6, s71, 12
    s_add_u32 s6, s6, s61
    s_add_u32 s71, s71, 1
    s_cmp_eq_u32 s71, 7
    s_cselect_b32 s71, 0, s71
    buffer_load_dwordx4 v[192:195], v1, s[36:39], s6 offen offset:0 sc1
    s_waitcnt vmcnt(13) lgkmcnt(4)
    v_mfma_f32_32x32x16_bf16 v[48:63], a[16:19], v[156:159], v[48:63]
    ds_read_b64_tr_b16 a[8:9], v8 offset:4096
    ds_read_b64_tr_b16 a[10:11], v8 offset:5120
    ds_read_b64_tr_b16 a[12:13], v9 offset:4096
    ds_read_b64_tr_b16 a[14:15], v9 offset:5120
    v_mfma_f32_32x32x16_bf16 v[64:79], a[20:23], v[156:159], v[64:79]
    buffer_load_dwordx4 v[196:199], v1, s[36:39], s6 offen offset:1024 sc1
    s_waitcnt vmcnt(13) lgkmcnt(4)
    v_mfma_f32_32x32x16_bf16 v[48:63], a[0:3], v[160:163], v[48:63]
    ds_read_b64_tr_b16 a[16:17], v8 offset:8192
    ds_read_b64_tr_b16 a[18:19], v8 offset:9216
    ds_read_b64_tr_b16 a[20:21], v9 offset:8192
    ds_read_b64_tr_b16 a[22:23], v9 offset:9216
    v_mfma_f32_32x32x16_bf16 v[64:79], a[4:7], v[160:163], v[64:79]
    buffer_load_dwordx4 v[200:203], v1, s[36:39], s6 offen offset:2048 sc1
    s_waitcnt vmcnt(13) lgkmcnt(4)
    v_mfma_f32_32x32x16_bf16 v[48:63], a[8:11], v[164:167], v[48:63]
    ds_read_b64_tr_b16 a[0:1], v8 offset:12288
    ds_read_b64_tr_b16 a[2:3], v8 offset:13312
    ds_read_b64_tr_b16 a[4:5], v9 offset:12288
    ds_read_b64_tr_b16 a[6:7], v9 offset:13312
    v_mfma_f32_32x32x16_bf16 v[64:79], a[12:15], v[164:167], v[64:79]
    buffer_load_dwordx4 v[204:207], v1, s[36:39], s6 offen offset:3072 sc1
    s_barrier
    s_waitcnt vmcnt(13) lgkmcnt(4)
    v_mfma_f32_32x32x16_bf16 v[48:63], a[16:19], v[168:171], v[48:63]
    ds_read_b64_tr_b16 a[8:9], v8 offset:32768
    ds_read_b64_tr_b16 a[10:11], v8 offset:33792
    ds_read_b64_tr_b16 a[12:13], v9 offset:32768
    ds_read_b64_tr_b16 a[14:15], v9 offset:33792
    v_mfma_f32_32x32x16_bf16 v[64:79], a[20:23], v[168:171], v[64:79]
    s_lshl_b32 s6, s71, 12
    s_add_u32 s6, s6, s61
    s_add_u32 s71, s71, 1
    s_cmp_eq_u32 s71, 7
    s_cselect_b32 s71, 0, s71
    buffer_load_dwordx4 v[208:211], v1, s[36:39], s6 offen offset:0 sc1
    s_waitcnt vmcnt(9) lgkmcnt(4)
    v_mfma_f32_32x32x16_bf16 v[48:63], a[0:3], v[172:175], v[48:63]
    ds_read_b64_tr_b16 a[16:17], v8 offset:36864
    ds_read_b64_tr_b16 a[18:19], v8 offset:37888
    ds_read_b64_tr_b16 a[20:21], v9 offset:36864
    ds_read_b64_tr_b16 a[22:23], v9 offset:37888
    v_mfma_f32_32x32x16_bf16 v[64:79], a[4:7], v[172:175], v[64:79]
    buffer_load_dwordx4 v[212:215], v1, s[36:39], s6 offen offset:1024 sc1
    s_waitcnt vmcnt(9) lgkmcnt(4)
    v_mfma_f32_32x32x16_bf16 v[48:63], a[8:11], v[176:179], v[48:63]
    ds_read_b64_tr_b16 a[0:1], v8 offset:40960
    ds_read_b64_tr_b16 a[2:3], v8 offset:41984
    ds_read_b64_tr_b16 a[4:5], v9 offset:40960
    ds_read_b64_tr_b16 a[6:7], v9 offset:41984
    v_mfma_f32_32x32x16_bf16 v[64:79], a[12:15], v[176:179], v[64:79]
    buffer_load_dwordx4 v[216:219], v1, s[36:39], s6 offen offset:2048 sc1
    v_and_b32 v31, 7, v0
    v_min_u32 v31, 6, v31
    v_lshlrev_b32 v31, 2, v31
    buffer_load_dword v2, v31, s[36:39], s69 offen offset:32 sc1
    s_waitcnt vmcnt(10) lgkmcnt(4)
    v_mfma_f32_32x32x16_bf16 v[48:63], a[16:19], v[180:183], v[48:63]
    ds_read_b64_tr_b16 a[8:9], v8 offset:45056
    ds_read_b64_tr_b16 a[10:11], v8 offset:46080
    ds_read_b64_tr_b16 a[12:13], v9 offset:45056
    ds_read_b64_tr_b16 a[14:15], v9 offset:46080
    v_mfma_f32_32x32x16_bf16 v[64:79], a[20:23], v[180:183], v[64:79]
    buffer_load_dwordx4 v[220:223], v1, s[36:39], s6 offen offset:3072 sc1
    s_barrier
    s_waitcnt vmcnt(10) lgkmcnt(4)
    v_mfma_f32_32x32x16_bf16 v[48:63], a[0:3], v[184:187], v[48:63]
    ds_read_b64_tr_b16 a[16:17], v8 offset:49152
    ds_read_b64_tr_b16 a[18:19], v8 offset:50176
    ds_read_b64_tr_b16 a[20:21], v9 offset:49152
    ds_read_b64_tr_b16 a[22:23], v9 offset:50176
    v_mfma_f32_32x32x16_bf16 v[64:79], a[4:7], v[184:187], v[64:79]
    s_waitcnt vmcnt(9) lgkmcnt(4)
    v_mfma_f32_32x32x16_bf16 v[48:63], a[8:11], v[188:191], v[48:63]
    ds_read_b64_tr_b16 a[0:1], v8 offset:53248
    ds_read_b64_tr_b16 a[2:3], v8 offset:54272
    ds_read_b64_tr_b16 a[4:5], v9 offset:53248
    ds_read_b64_tr_b16 a[6:7], v9 offset:54272
    v_mfma_f32_32x32x16_bf16 v[64:79], a[12:15], v[188:191], v[64:79]
    s_waitcnt vmcnt(8) lgkmcnt(4)
    v_mfma_f32_32x32x16_bf16 v[48:63], a[16:19], v[192:195], v[48:63]
    ds_read_b64_tr_b16 a[8:9], v8 offset:57344
    ds_read_b64_tr_b16 a[10:11], v8 offset:58368
    ds_read_b64_tr_b16 a[12:13], v9 offset:57344
    ds_read_b64_tr_b16 a[14:15], v9 offset:58368
    v_mfma_f32_32x32x16_bf16 v[64:79], a[20:23], v[192:195], v[64:79]
    s_waitcnt vmcnt(7) lgkmcnt(4)
    v_mfma_f32_32x32x16_bf16 v[48:63], a[0:3], v[196:199], v[48:63]
    ds_read_b64_tr_b16 a[16:17], v8 offset:61440
    ds_read_b64_tr_b16 a[18:19], v8 offset:62464
    ds_read_b64_tr_b16 a[20:21], v9 offset:61440
    ds_read_b64_tr_b16 a[22:23], v9 offset:62464
    v_mfma_f32_32x32x16_bf16 v[64:79], a[4:7], v[196:199], v[64:79]
    s_waitcnt vmcnt(1)
    v_cmp_ne_u32 vcc, s67, v2
    s_cbranch_vccnz LS_h1
LB_h1:
    s_nop 4
    s_lshl_b32 s6, s71, 12
    s_add_u32 s6, s6, s61
    s_add_u32 s71, s71, 1
    s_barrier
    s_waitcnt lgkmcnt(4)
    v_mfma_f32_32x32x16_bf16 v[48:63], a[8:11], v[200:203], v[48:63]
    ds_read_b64_tr_b16 a[0:1], v10 offset:0
    ds_read_b64_tr_b16 a[2:3], v10 offset:1024
    ds_read_b64_tr_b16 a[4:5], v11 offset:0
    ds_read_b64_tr_b16 a[6:7], v11 offset:1024
    v_mfma_f32_32x32x16_bf16 v[64:79], a[12:15], v[200:203], v[64:79]
    s_cmp_eq_u32 s71, 7
    s_cselect_b32 s71, 0, s71
    s_add_u32 s6, s6, 28672
    buffer_load_dwordx4 v[112:115], v1, s[36:39], s6 offen offset:0 sc1
    buffer_load_dwordx4 v[116:119], v1, s[36:39], s6 offen offset:1024 sc1
    buffer_load_dwordx4 v[120:123], v1, s[36:39], s6 offen offset:2048 sc1
    s_waitcnt lgkmcnt(4)
    v_mfma_f32_32x32x16_bf16 v[48:63], a[16:19], v[204:207], v[48:63]
    ds_read_b64_tr_b16 a[8:9], v10 offset:4096
    ds_read_b64_tr_b16 a[10:11], v10 offset:5120
    ds_read_b64_tr_b16 a[12:13], v11 offset:4096
    ds_read_b64_tr_b16 a[14:15], v11 offset:5120
    v_mfma_f32_32x32x16_bf16 v[64:79], a[20:23], v[204:207], v[64:79]
    buffer_load_dwordx4 v[124:127], v1, s[36:39], s6 offen offset:3072 sc1
    s_lshl_b32 s6, s71, 12
    s_add_u32 s6, s6, s61
    s_add_u32 s71, s71, 1
    s_cmp_eq_u32 s71, 7
    s_cselect_b32 s71, 0, s71
    s_waitcnt lgkmcnt(4)
    v_mfma_f32_32x32x16_bf16 v[48:63], a[0:3], v[208:211], v[48:63]
    ds_read_b64_tr_b16 a[16:17], v10 offset:8192
    ds_read_b64_tr_b16 a[18:19], v10 offset:9216
    ds_read_b64_tr_b16 a[20:21], v11 offset:8192
    ds_read_b64_tr_b16 a[22:23], v11 offset:9216
    v_mfma_f32_32x32x16_bf16 v[64:79], a[4:7], v[208:211], v[64:79]
    s_add_u32 s6, s6, 28672
    buffer_load_dwordx4 v[128:131], v1, s[36:39], s6 offen offset:0 sc1
    buffer_load_dwordx4 v[132:135], v1, s[36:39], s6 offen offset:1024 sc1
    buffer_load_dwordx4 v[136:139], v1, s[36:39], s6 offen offset:2048 sc1
    buffer_load_dwordx4 v[140:143], v1, s[36:39], s6 offen offset:3072 sc1
    s_waitcnt lgkmcnt(4)
    v_mfma_f32_32x32x16_bf16 v[48:63], a[8:11], v[212:215], v[48:63]
    ds_read_b64_tr_b16 a[0:1], v10 offset:12288
    ds_read_b64_tr_b16 a[2:3], v10 offset:13312
    ds_read_b64_tr_b16 a[4:5], v11 offset:12288
    ds_read_b64_tr_b16 a[6:7], v11 offset:13312
    v_mfma_f32_32x32x16_bf16 v[64:79], a[12:15], v[212:215], v[64:79]
    s_lshl_b32 s6, s71, 12
    s_add_u32 s6, s6, s61
    s_add_u32 s71, s71, 1
    s_cmp_eq_u32 s71, 7
    s_cselect_b32 s71, 0, s71
    s_add_u32 s6, s6, 28672
    s_barrier
    s_waitcnt lgkmcnt(4)
    v_mfma_f32_32x32x16_bf16 v[48:63], a[16:19], v[216:219], v[48:63]
    ds_read_b64_tr_b16 a[8:9], v6 offset:16384
    ds_read_b64_tr_b16 a[10:11], v6 offset:17408
    ds_read_b64_tr_b16 a[12:13], v7 offset:16384
    ds_read_b64_tr_b16 a[14:15], v7 offset:17408
    v_mfma_f32_32x32x16_bf16 v[64:79], a[20:23], v[216:219], v[64:79]
    buffer_load_dwordx4 v[144:147], v1, s[36:39], s6 offen offset:0 sc1
    buffer_load_dwordx4 v[148:151], v1, s[36:39], s6 offen offset:1024 sc1
    buffer_load_dwordx4 v[152:155], v1, s[36:39], s6 offen offset:2048 sc1
    buffer_load_dwordx4 v[156:159], v1, s[36:39], s6 offen offset:3072 sc1
    s_lshl_b32 s6, s71, 12
    s_waitcnt vmcnt(12) lgkmcnt(4)
    v_mfma_f32_32x32x16_bf16 v[48:63], a[0:3], v[220:223], v[48:63]
    ds_read_b64_tr_b16 a[16:17], v6 offset:20480
    ds_read_b64_tr_b16 a[18:19], v6 offset:21504
    ds_read_b64_tr_b16 a[20:21], v7 offset:20480
    ds_read_b64_tr_b16 a[22:23], v7 offset:21504
    v_mfma_f32_32x32x16_bf16 v[64:79], a[4:7], v[220:223], v[64:79]
    s_add_u32 s6, s6, s61
    s_add_u32 s71, s71, 1
    s_cmp_eq_u32 s71, 7
    s_cselect_b32 s71, 0, s71
    s_add_u32 s6, s6, 28672
    buffer_load_dwordx4 v[160:163], v1, s[36:39], s6 offen offset:0 sc1
    s_waitcnt vmcnt(12) lgkmcnt(4)
    v_mfma_f32_32x32x16_bf16 v[48:63], a[8:11], v[112:115], v[48:63]
    ds_read_b64_tr_b16 a[0:1], v6 offset:24576
    ds_read_b64_tr_b16 a[2:3], v6 offset:25600
    ds_read_b64_tr_b16 a[4:5], v7 offset:24576
    ds_read_b64_tr_b16 a[6:7], v7 offset:25600
    v_mfma_f32_32x32x16_bf16 v[64:79], a[12:15], v[112:115], v[64:79]
    buffer_load_dwordx4 v[164:167], v1, s[36:39], s6 offen offset:1024 sc1
    buffer_load_dwordx4 v[168:171], v1, s[36:39], s6 offen offset:2048 sc1
    buffer_load_dwordx4 v[172:175], v1, s[36:39], s6 offen offset:3072 sc1
    s_lshl_b32 s6, s71, 12
    s_add_u32 s6, s6, s61
    s_waitcnt vmcnt(14) lgkmcnt(4)
    v_mfma_f32_32x32x16_bf16 v[48:63], a[16:19], v[116:119], v[48:63]
    ds_read_b64_tr_b16 a[8:9], v6 offset:28672
    ds_read_b64_tr_b16 a[10:11], v6 offset:29696
    ds_read_b64_tr_b16 a[12:13], v7 offset:28672
    ds_read_b64_tr_b16 a[14:15], v7 offset:29696
    v_mfma_f32_32x32x16_bf16 v[64:79], a[20:23], v[116:119], v[64:79]
    s_add_u32 s71, s71, 1
    s_cmp_eq_u32 s71, 7
    s_cselect_b32 s71, 0, s71
    s_add_u32 s6, s6, 28672
    buffer_load_dwordx4 v[176:179], v1, s[36:39], s6 offen offset:0 sc1
    buffer_load_dwordx4 v[180:183], v1, s[36:39], s6 offen offset:1024 sc1
    s_barrier
    s_waitcnt vmcnt(15) lgkmcnt(4)
    v_mfma_f32_32x32x16_bf16 v[48:63], a[0:3], v[120:123], v[48:63]
    ds_read_b64_tr_b16 a[16:17], v6 offset:32768
    ds_read_b64_tr_b16 a[18:19], v6 offset:33792
    ds_read_b64_tr_b16 a[20:21], v7 offset:32768
    ds_read_b64_tr_b16 a[22:23], v7 offset:33792
    v_mfma_f32_32x32x16_bf16 v[64:79], a[4:7], v[120:123], v[64:79]
    buffer_load_dwordx4 v[184:187], v1, s[36:39], s6 offen offset:2048 sc1
    buffer_load_dwordx4 v[188:191], v1, s[36:39], s6 offen offset:3072 sc1
    s_lshl_b32 s6, s71, 12
    s_add_u32 s6, s6, s61
    s_add_u32 s71, s71, 1
    s_waitcnt vmcnt(16) lgkmcnt(4)
    v_mfma_f32_32x32x16_bf16 v[48:63], a[8:11], v[124:127], v[48:63]
    ds_read_b64_tr_b16 a[0:1], v6 offset:36864
    ds_read_b64_tr_b16 a[2:3], v6 offset:37888
    ds_read_b64_tr_b16 a[4:5], v7 offset:36864
    ds_read_b64_tr_b16 a[6:7], v7 offset:37888
    v_mfma_f32_32x32x16_bf16 v[64:79], a[12:15], v[124:127], v[64:79]
    s_cmp_eq_u32 s71, 7
    s_cselect_b32 s71, 0, s71
    s_add_u32 s6, s6, 28672
    buffer_load_dwordx4 v[192:195], v1, s[36:39], s6 offen offset:0 sc1
    buffer_load_dwordx4 v[196:199], v1, s[36:39], s6 offen offset:1024 sc1
    buffer_load_dwordx4 v[200:203], v1, s[36:39], s6 offen offset:2048 sc1
    s_waitcnt vmcnt(18) lgkmcnt(4)
    v_mfma_f32_32x32x16_bf16 v[48:63], a[16:19], v[128:131], v[48:63]
    ds_read_b64_tr_b16 a[8:9], v6 offset:40960
    ds_read_b64_tr_b16 a[10:11], v6 offset:41984
    ds_read_b64_tr_b16 a[12:13], v7 offset:40960
    ds_read_b64_tr_b16 a[14:15], v7 offset:41984
    v_mfma_f32_32x32x16_bf16 v[64:79], a[20:23], v[128:131], v[64:79]
    buffer_load_dwordx4 v[204:207], v1, s[36:39], s6 offen offset:3072 sc1
    s_lshl_b32 s6, s71, 12
    s_add_u32 s6, s6, s61
    s_add_u32 s71, s71, 1
    s_cmp_eq_u32 s71, 7
    s_cselect_b32 s71, 0, s71
    s_waitcnt vmcnt(18) lgkmcnt(4)
    v_mfma_f32_32x32x16_bf16 v[48:63], a[0:3], v[132:135], v[48:63]
    ds_read_b64_tr_b16 a[16:17], v6 offset:45056
    ds_read_b64_tr_b16 a[18:19], v6 offset:46080
    ds_read_b64_tr_b16 a[20:21], v7 offset:45056
    ds_read_b64_tr_b16 a[22:23], v7 offset:46080
    v_mfma_f32_32x32x16_bf16 v[64:79], a[4:7], v[132:135], v[64:79]
    s_add_u32 s6, s6, 28672
    buffer_load_dwordx4 v[208:211], v1, s[36:39], s6 offen offset:0 sc1
    buffer_load_dwordx4 v[212:215], v1, s[36:39], s6 offen offset:1024 sc1
    buffer_load_dwordx4 v[216:219], v1, s[36:39], s6 offen offset:2048 sc1
    buffer_load_dwordx4 v[220:223], v1, s[36:39], s6 offen offset:3072 sc1
    s_barrier
    s_waitcnt vmcnt(21) lgkmcnt(4)
    v_mfma_f32_32x32x16_bf16 v[48:63], a[8:11], v[136:139], v[48:63]
    ds_read_b64_tr_b16 a[0:1], v8 offset:0
    ds_read_b64_tr_b16 a[2:3], v8 offset:1024
    ds_read_b64_tr_b16 a[4:5], v9 offset:0
    ds_read_b64_tr_b16 a[6:7], v9 offset:1024
    v_mfma_f32_32x32x16_bf16 v[64:79], a[12:15], v[136:139], v[64:79]
    s_waitcnt vmcnt(20) lgkmcnt(4)
    v_mfma_f32_32x32x16_bf16 v[48:63], a[16:19], v[140:143], v[48:63]
    ds_read_b64_tr_b16 a[8:9], v8 offset:4096
    ds_read_b64_tr_b16 a[10:11], v8 offset:5120
    ds_read_b64_tr_b16 a[12:13], v9 offset:4096
    ds_read_b64_tr_b16 a[14:15], v9 offset:5120
    v_mfma_f32_32x32x16_bf16 v[64:79], a[20:23], v[140:143], v[64:79]
    s_waitcnt vmcnt(19) lgkmcnt(4)
    v_mfma_f32_32x32x16_bf16 v[48:63], a[0:3], v[144:147], v[48:63]
    ds_read_b64_tr_b16 a[16:17], v8 offset:8192
    ds_read_b64_tr_b16 a[18:19], v8 offset:9216
    ds_read_b64_tr_b16 a[20:21], v9 offset:8192
    ds_read_b64_tr_b16 a[22:23], v9 offset:9216
    v_mfma_f32_32x32x16_bf16 v[64:79], a[4:7], v[144:147], v[64:79]
    s_waitcnt vmcnt(18) lgkmcnt(4)
    v_mfma_f32_32x32x16_bf16 v[48:63], a[8:11], v[148:151], v[48:63]
    ds_read_b64_tr_b16 a[0:1], v8 offset:12288
    ds_read_b64_tr_b16 a[2:3], v8 offset:13312
    ds_read_b64_tr_b16 a[4:5], v9 offset:12288
    ds_read_b64_tr_b16 a[6:7], v9 offset:13312
    v_mfma_f32_32x32x16_bf16 v[64:79], a[12:15], v[148:151], v[64:79]
    s_barrier
    s_waitcnt vmcnt(17) lgkmcnt(4)
    v_mfma_f32_32x32x16_bf16 v[48:63], a[16:19], v[152:155], v[48:63]
    ds_read_b64_tr_b16 a[8:9], v8 offset:16384
    ds_read_b64_tr_b16 a[10:11], v8 offset:17408
    ds_read_b64_tr_b16 a[12:13], v9 offset:16384
    ds_read_b64_tr_b16 a[14:15], v9 offset:17408
    v_mfma_f32_32x32x16_bf16 v[64:79], a[20:23], v[152:155], v[64:79]
    s_waitcnt vmcnt(16) lgkmcnt(4)
    v_mfma_f32_32x32x16_bf16 v[48:63], a[0:3], v[156:159], v[48:63]
    ds_read_b64_tr_b16 a[16:17], v8 offset:20480
    ds_read_b64_tr_b16 a[18:19], v8 offset:21504
    ds_read_b64_tr_b16 a[20:21], v9 offset:20480
    ds_read_b64_tr_b16 a[22:23], v9 offset:21504
    v_mfma_f32_32x32x16_bf16 v[64:79], a[4:7], v[156:159], v[64:79]
    s_waitcnt vmcnt(15) lgkmcnt(4)
    v_mfma_f32_32x32x16_bf16 v[48:63], a[8:11], v[160:163], v[48:63]
    ds_read_b64_tr_b16 a[0:1], v8 offset:24576
    ds_read_b64_tr_b16 a[2:3], v8 offset:25600
    ds_read_b64_tr_b16 a[4:5], v9 offset:24576
    ds_read_b64_tr_b16 a[6:7], v9 offset:25600
    v_mfma_f32_32x32x16_bf16 v[64:79], a[12:15], v[160:163], v[64:79]
    s_waitcnt vmcnt(14) lgkmcnt(4)
    v_mfma_f32_32x32x16_bf16 v[48:63], a[16:19], v[164:167], v[48:63]
    ds_read_b64_tr_b16 a[8:9], v8 offset:28672
    ds_read_b64_tr_b16 a[10:11], v8 offset:29696
    ds_read_b64_tr_b16 a[12:13], v9 offset:28672
    ds_read_b64_tr_b16 a[14:15], v9 offset:29696
    v_mfma_f32_32x32x16_bf16 v[64:79], a[20:23], v[164:167], v[64:79]
    s_barrier
    s_waitcnt vmcnt(13) lgkmcnt(4)
    v_mfma_f32_32x32x16_bf16 v[48:63], a[0:3], v[168:171], v[48:63]
    ds_read_b64_tr_b16 a[16:17], v8 offset:32768
    ds_read_b64_tr_b16 a[18:19], v8 offset:33792
    ds_read_b64_tr_b16 a[20:21], v9 offset:32768
    ds_read_b64_tr_b16 a[22:23], v9 offset:33792
    v_mfma_f32_32x32x16_bf16 v[64:79], a[4:7], v[168:171], v[64:79]
    s_waitcnt vmcnt(12) lgkmcnt(4)
    v_mfma_f32_32x32x16_bf16 v[48:63], a[8:11], v[172:175], v[48:63]
    ds_read_b64_tr_b16 a[0:1], v8 offset:36864
    ds_read_b64_tr_b16 a[2:3], v8 offset:37888
    ds_read_b64_tr_b16 a[4:5], v9 offset:36864
    ds_read_b64_tr_b16 a[6:7], v9 offset:37888
    v_mfma_f32_32x32x16_bf16 v[64:79], a[12:15], v[172:175], v[64:79]
    s_waitcnt vmcnt(11) lgkmcnt(4)
    v_mfma_f32_32x32x16_bf16 v[48:63], a[16:19], v[176:179], v[48:63]
    ds_read_b64_tr_b16 a[8:9], v8 offset:40960
    ds_read_b64_tr_b16 a[10:11], v8 offset:41984
    ds_read_b64_tr_b16 a[12:13], v9 offset:40960
    ds_read_b64_tr_b16 a[14:15], v9 offset:41984
    v_mfma_f32_32x32x16_bf16 v[64:79], a[20:23], v[176:179], v[64:79]
    v_lshlrev_b32 v80, 16, v96
    v_and_b32 v81, 0xffff0000, v96
    v_lshlrev_b32 v82, 16, v97
    v_and_b32 v83, 0xffff0000, v97
    v_lshlrev_b32 v84, 16, v98
    s_waitcnt vmcnt(10) lgkmcnt(4)
    v_mfma_f32_32x32x16_bf16 v[48:63], a[0:3], v[180:183], v[48:63]
    ds_read_b64_tr_b16 a[16:17], v8 offset:45056
    ds_read_b64_tr_b16 a[18:19], v8 offset:46080
    ds_read_b64_tr_b16 a[20:21], v9 offset:45056
    ds_read_b64_tr_b16 a[22:23], v9 offset:46080
    v_mfma_f32_32x32x16_bf16 v[64:79], a[4:7], v[180:183], v[64:79]
    v_and_b32 v85, 0xffff0000, v98
    v_lshlrev_b32 v86, 16, v99
    v_and_b32 v87, 0xffff0000, v99
    v_lshlrev_b32 v88, 16, v100
    v_and_b32 v89, 0xffff0000, v100
    s_barrier
    s_waitcnt vmcnt(9) lgkmcnt(4)
    v_mfma_f32_32x32x16_bf16 v[48:63], a[8:11], v[184:187], v[48:63]
    ds_read_b64_tr_b16 a[0:1], v8 offset:49152
    ds_read_b64_tr_b16 a[2:3], v8 offset:50176
    ds_read_b64_tr_b16 a[4:5], v9 offset:49152
    ds_read_b64_tr_b16 a[6:7], v9 offset:50176
    v_mfma_f32_32x32x16_bf16 v[64:79], a[12:15], v[184:187], v[64:79]
    v_lshlrev_b32 v90, 16, v101
    v_and_b32 v91, 0xffff0000, v101
    v_lshlrev_b32 v92, 16, v102
    v_and_b32 v93, 0xffff0000, v102
    v_lshlrev_b32 v94, 16, v103
    s_waitcnt vmcnt(8) lgkmcnt(4)
    v_mfma_f32_32x32x16_bf16 v[48:63], a[16:19], v[188:191], v[48:63]
    ds_read_b64_tr_b16 a[8:9], v8 offset:53248
    ds_read_b64_tr_b16 a[10:11], v8 offset:54272
    ds_read_b64_tr_b16 a[12:13], v9 offset:53248
    ds_read_b64_tr_b16 a[14:15], v9 offset:54272
    v_mfma_f32_32x32x16_bf16 v[64:79], a[20:23], v[188:191], v[64:79]
    v_and_b32 v95, 0xffff0000, v103
    s_waitcnt vmcnt(7) lgkmcnt(4)
    v_mfma_f32_32x32x16_bf16 v[48:63], a[0:3], v[192:195], v[48:63]
    ds_read_b64_tr_b16 a[16:17], v8 offset:57344
    ds_read_b64_tr_b16 a[18:19], v8 offset:58368
    ds_read_b64_tr_b16 a[20:21], v9 offset:57344
    ds_read_b64_tr_b16 a[22:23], v9 offset:58368
    v_mfma_f32_32x32x16_bf16 v[64:79], a[4:7], v[192:195], v[64:79]
    s_waitcnt vmcnt(6) lgkmcnt(4)
    v_mfma_f32_32x32x16_bf16 v[48:63], a[8:11], v[196:199], v[48:63]
    ds_read_b64_tr_b16 a[0:1], v8 offset:61440
    ds_read_b64_tr_b16 a[2:3], v8 offset:62464
    ds_read_b64_tr_b16 a[4:5], v9 offset:61440
    ds_read_b64_tr_b16 a[6:7], v9 offset:62464
    v_mfma_f32_32x32x16_bf16 v[64:79], a[12:15], v[196:199], v[64:79]
    s_barrier
    s_waitcnt vmcnt(5) lgkmcnt(4)
    v_mfma_f32_32x32x16_bf16 v[48:63], a[16:19], v[200:203], v[48:63]
    ds_read_b64_tr_b16 a[8:9], v10 offset:0
    ds_read_b64_tr_b16 a[10:11], v10 offset:1024
    ds_read_b64_tr_b16 a[12:13], v11 offset:0
    ds_read_b64_tr_b16 a[14:15], v11 offset:1024
    v_mfma_f32_32x32x16_bf16 v[64:79], a[20:23], v[200:203], v[64:79]
    s_waitcnt vmcnt(4) lgkmcnt(4)
    v_mfma_f32_32x32x16_bf16 v[48:63], a[0:3], v[204:207], v[48:63]
    ds_read_b64_tr_b16 a[16:17], v10 offset:4096
    ds_read_b64_tr_b16 a[18:19], v10 offset:5120
    ds_read_b64_tr_b16 a[20:21], v11 offset:4096
    ds_read_b64_tr_b16 a[22:23], v11 offset:5120
    v_mfma_f32_32x32x16_bf16 v[64:79], a[4:7], v[204:207], v[64:79]
    s_waitcnt vmcnt(3) lgkmcnt(4)
    v_mfma_f32_32x32x16_bf16 v[48:63], a[8:11], v[208:211], v[48:63]
    ds_read_b64_tr_b16 a[0:1], v10 offset:8192
    ds_read_b64_tr_b16 a[2:3], v10 offset:9216
    ds_read_b64_tr_b16 a[4:5], v11 offset:8192
    ds_read_b64_tr_b16 a[6:7], v11 offset:9216
    v_mfma_f32_32x32x16_bf16 v[64:79], a[12:15], v[208:211], v[64:79]
    s_waitcnt vmcnt(2) lgkmcnt(4)
    v_mfma_f32_32x32x16_bf16 v[48:63], a[16:19], v[212:215], v[48:63]
    ds_read_b64_tr_b16 a[8:9], v10 offset:12288
    ds_read_b64_tr_b16 a[10:11], v10 offset:13312
    ds_read_b64_tr_b16 a[12:13], v11 offset:12288
    ds_read_b64_tr_b16 a[14:15], v11 offset:13312
    v_mfma_f32_32x32x16_bf16 v[64:79], a[20:23], v[212:215], v[64:79]
    s_waitcnt vmcnt(1) lgkmcnt(4)
    v_mfma_f32_32x32x16_bf16 v[48:63], a[0:3], v[216:219], v[48:63]
    v_mfma_f32_32x32x16_bf16 v[64:79], a[4:7], v[216:219], v[64:79]
    s_waitcnt vmcnt(0) lgkmcnt(0)
    v_mfma_f32_32x32x16_bf16 v[48:63], a[8:11], v[220:223], v[48:63]
    v_mfma_f32_32x32x16_bf16 v[64:79], a[12:15], v[220:223], v[64:79]
    s_nop 11
    ds_write_b128 v13, v[64:67] offset:49152
    ds_write_b128 v13, v[68:71] offset:50176
    ds_write_b128 v13, v[72:75] offset:51200
    ds_write_b128 v13, v[76:79] offset:52224
    s_waitcnt lgkmcnt(0)
    s_barrier
    ds_read_b128 v[64:67], v14 offset:49152
    ds_read_b128 v[68:71], v14 offset:50176
    ds_read_b128 v[72:75], v14 offset:51200
    ds_read_b128 v[76:79], v14 offset:52224
    s_waitcnt lgkmcnt(2)
    v_add_f32 v48, v48, v64
    v_add_f32 v49, v49, v65
    v_add_f32 v50, v50, v66
    v_add_f32 v51, v51, v67
    v_add_f32 v52, v52, v68
    v_add_f32 v53, v53, v69
    v_add_f32 v54, v54, v70
    v_add_f32 v55, v55, v71
    v_mul_f32 v32, 0xbfb8aa3b, v48
    v_mul_f32 v33, 0xbfb8aa3b, v49
    v_mul_f32 v34, 0xbfb8aa3b, v50
    v_mul_f32 v35, 0xbfb8aa3b, v51
    v_mul_f32 v36, 0xbfb8aa3b, v52
    v_mul_f32 v37, 0xbfb8aa3b, v53
    v_mul_f32 v38, 0xbfb8aa3b, v54
    v_mul_f32 v39, 0xbfb8aa3b, v55
    v_exp_f32 v32, v32
    v_exp_f32 v33, v33
    v_exp_f32 v34, v34
    v_exp_f32 v35, v35
    v_exp_f32 v36, v36
    v_exp_f32 v37, v37
    v_exp_f32 v38, v38
    v_exp_f32 v39, v39
    v_add_f32 v32, 1.0, v32
    v_add_f32 v33, 1.0, v33
    v_add_f32 v34, 1.0, v34
    v_add_f32 v35, 1.0, v35
    v_add_f32 v36, 1.0, v36
    v_add_f32 v37, 1.0, v37
    v_add_f32 v38, 1.0, v38
    v_add_f32 v39, 1.0, v39
    v_rcp_f32 v32, v32
    v_rcp_f32 v33, v33
    v_rcp_f32 v34, v34
    v_rcp_f32 v35, v35
    v_rcp_f32 v36, v36
    v_rcp_f32 v37, v37
    v_rcp_f32 v38, v38
    v_rcp_f32 v39, v39
    v_mul_f32 v48, v48, v32
    v_mul_f32 v49, v49, v33
    v_mul_f32 v50, v50, v34
    v_mul_f32 v51, v51, v35
    v_mul_f32 v52, v52, v36
    v_mul_f32 v53, v53, v37
    v_mul_f32 v54, v54, v38
    v_mul_f32 v55, v55, v39
    s_waitcnt lgkmcnt(0)
    v_add_f32 v56, v56, v72
    v_add_f32 v57, v57, v73
    v_add_f32 v58, v58, v74
    v_add_f32 v59, v59, v75
    v_add_f32 v60, v60, v76
    v_add_f32 v61, v61, v77
    v_add_f32 v62, v62, v78
    v_add_f32 v63, v63, v79
    v_mul_f32 v32, 0xbfb8aa3b, v56
    v_mul_f32 v33, 0xbfb8aa3b, v57
    v_mul_f32 v34, 0xbfb8aa3b, v58
    v_mul_f32 v35, 0xbfb8aa3b, v59
    v_mul_f32 v36, 0xbfb8aa3b, v60
    v_mul_f32 v37, 0xbfb8aa3b, v61
    v_mul_f32 v38, 0xbfb8aa3b, v62
    v_mul_f32 v39, 0xbfb8aa3b, v63
    v_exp_f32 v32, v32
    v_exp_f32 v33, v33
    v_exp_f32 v34, v34
    v_exp_f32 v35, v35
    v_exp_f32 v36, v36
    v_exp_f32 v37, v37
    v_exp_f32 v38, v38
    v_exp_f32 v39, v39
    v_add_f32 v32, 1.0, v32
    v_add_f32 v33, 1.0, v33
    v_add_f32 v34, 1.0, v34
    v_add_f32 v35, 1.0, v35
    v_add_f32 v36, 1.0, v36
    v_add_f32 v37, 1.0, v37
    v_add_f32 v38, 1.0, v38
    v_add_f32 v39, 1.0, v39
    v_rcp_f32 v32, v32
    v_rcp_f32 v33, v33
    v_rcp_f32 v34, v34
    v_rcp_f32 v35, v35
    v_rcp_f32 v36, v36
    v_rcp_f32 v37, v37
    v_rcp_f32 v38, v38
    v_rcp_f32 v39, v39
    v_mul_f32 v56, v56, v32
    v_mul_f32 v57, v57, v33
    v_mul_f32 v58, v58, v34
    v_mul_f32 v59, v59, v35
    v_mul_f32 v60, v60, v36
    v_mul_f32 v61, v61, v37
    v_mul_f32 v62, v62, v38
    v_mul_f32 v63, v63, v39
    s_lshl_b32 s64, s52, 12
    s_add_u32 s64, s64, 98304
    v_add_u32 v32, s64, v1
    s_barrier
    ds_read_b128 v[64:67], v32 offset:0
    ds_read_b128 v[68:71], v32 offset:1024
    ds_read_b128 v[72:75], v32 offset:2048
    ds_read_b128 v[76:79], v32 offset:3072
    s_waitcnt lgkmcnt(3)
    v_fma_f32 v80, v64, v48, v80
    v_fma_f32 v81, v65, v49, v81
    v_fma_f32 v82, v66, v50, v82
    v_fma_f32 v83, v67, v51, v83
    v_cvt_pk_bf16_f32 v96, v80, v81
    v_cvt_pk_bf16_f32 v97, v82, v83
    buffer_store_dwordx2 v[96:97], v12, s[48:51], s62 offen offset:0
    s_waitcnt lgkmcnt(2)
    v_fma_f32 v84, v68, v52, v84
    v_fma_f32 v85, v69, v53, v85
    v_fma_f32 v86, v70, v54, v86
    v_fma_f32 v87, v71, v55, v87
    v_cvt_pk_bf16_f32 v98, v84, v85
    v_cvt_pk_bf16_f32 v99, v86, v87
    buffer_store_dwordx2 v[98:99], v12, s[48:51], s62 offen offset:16
    s_waitcnt lgkmcnt(1)
    v_fma_f32 v88, v72, v56, v88
    v_fma_f32 v89, v73, v57, v89
    v_fma_f32 v90, v74, v58, v90
    v_fma_f32 v91, v75, v59, v91
    v_cvt_pk_bf16_f32 v100, v88, v89
    v_cvt_pk_bf16_f32 v101, v90, v91
    buffer_store_dwordx2 v[100:101], v12, s[48:51], s62 offen offset:32
    s_waitcnt lgkmcnt(0)
    v_fma_f32 v92, v76, v60, v92
    v_fma_f32 v93, v77, v61, v93
    v_fma_f32 v94, v78, v62, v94
    v_fma_f32 v95, v79, v63, v95
    v_cvt_pk_bf16_f32 v102, v92, v93
    v_cvt_pk_bf16_f32 v103, v94, v95
    buffer_store_dwordx2 v[102:103], v12, s[48:51], s62 offen offset:48
L_done:
    s_endpgm
L_attn:
    s_nop 7
    s_nop 7
    ds_read_b64_tr_b16 a[0:1], v12 offset:16384
    ds_read_b64_tr_b16 a[2:3], v12 offset:18432
    ds_read_b64_tr_b16 a[4:5], v13 offset:16384
    ds_read_b64_tr_b16 a[6:7], v13 offset:18432
    ds_read_b64_tr_b16 a[8:9], v14 offset:16384
    ds_read_b64_tr_b16 a[10:11], v14 offset:18432
    ds_read_b64_tr_b16 a[12:13], v15 offset:16384
    ds_read_b64_tr_b16 a[14:15], v15 offset:18432
    s_lshl_b32 s66, s57, 15
    s_lshl_b32 s64, s54, 14
    s_add_u32 s66, s66, s64
    s_add_u32 s66, s66, 0x700000
    v_mul_f32 v32, v48, v27
    v_mul_f32 v33, v49, v27
    v_mul_f32 v34, v50, v27
    v_mul_f32 v35, v51, v27
    v_mul_f32 v36, v52, v27
    v_mul_f32 v37, v53, v27
    v_mul_f32 v38, v54, v27
    v_mul_f32 v39, v55, v27
    v_exp_f32_e64 v32, v32 clamp
    v_fmaak_f32 v48, v48, v26, 0x358637bd
    v_exp_f32_e64 v33, v33 clamp
    v_fmaak_f32 v49, v49, v26, 0x358637bd
    v_exp_f32_e64 v34, v34 clamp
    v_fmaak_f32 v50, v50, v26, 0x358637bd
    v_exp_f32_e64 v35, v35 clamp
    v_fmaak_f32 v51, v51, v26, 0x358637bd
    v_exp_f32_e64 v36, v36 clamp
    v_fmaak_f32 v52, v52, v26, 0x358637bd
    v_exp_f32_e64 v37, v37 clamp
    v_fmaak_f32 v53, v53, v26, 0x358637bd
    v_exp_f32_e64 v38, v38 clamp
    v_fmaak_f32 v54, v54, v26, 0x358637bd
    v_exp_f32_e64 v39, v39 clamp
    v_fmaak_f32 v55, v55, v26, 0x358637bd
    v_max_f32 v48, 0x358637bd, v48
    v_max_f32 v49, 0x358637bd, v49
    v_max_f32 v50, 0x358637bd, v50
    v_max_f32 v51, 0x358637bd, v51
    v_max_f32 v52, 0x358637bd, v52
    v_max_f32 v53, 0x358637bd, v53
    v_max_f32 v54, 0x358637bd, v54
    v_max_f32 v55, 0x358637bd, v55
    v_add_f32 v48, v48, v32
    v_add_f32 v49, v49, v33
    v_add_f32 v50, v50, v34
    v_add_f32 v51, v51, v35
    v_add_f32 v52, v52, v36
    v_add_f32 v53, v53, v37
    v_add_f32 v54, v54, v38
    v_add_f32 v55, v55, v39
    v_cvt_pk_bf16_f32 v40, v48, v49
    v_cvt_pk_bf16_f32 v41, v50, v51
    v_cvt_pk_bf16_f32 v42, v52, v53
    v_cvt_pk_bf16_f32 v43, v54, v55
    v_mul_f32 v32, v56, v27
    v_mul_f32 v33, v57, v27
    v_mul_f32 v34, v58, v27
    v_mul_f32 v35, v59, v27
    v_mul_f32 v36, v60, v27
    v_mul_f32 v37, v61, v27
    v_mul_f32 v38, v62, v27
    v_mul_f32 v39, v63, v27
    v_exp_f32_e64 v32, v32 clamp
    v_fmaak_f32 v56, v56, v26, 0x358637bd
    v_exp_f32_e64 v33, v33 clamp
    v_fmaak_f32 v57, v57, v26, 0x358637bd
    v_exp_f32_e64 v34, v34 clamp
    v_fmaak_f32 v58, v58, v26, 0x358637bd
    v_exp_f32_e64 v35, v35 clamp
    v_fmaak_f32 v59, v59, v26, 0x358637bd
    v_exp_f32_e64 v36, v36 clamp
    v_fmaak_f32 v60, v60, v26, 0x358637bd
    v_exp_f32_e64 v37, v37 clamp
    v_fmaak_f32 v61, v61, v26, 0x358637bd
    v_exp_f32_e64 v38, v38 clamp
    v_fmaak_f32 v62, v62, v26, 0x358637bd
    v_exp_f32_e64 v39, v39 clamp
    v_fmaak_f32 v63, v63, v26, 0x358637bd
    v_max_f32 v56, 0x358637bd, v56
    v_max_f32 v57, 0x358637bd, v57
    v_max_f32 v58, 0x358637bd, v58
    v_max_f32 v59, 0x358637bd, v59
    v_max_f32 v60, 0x358637bd, v60
    v_max_f32 v61, 0x358637bd, v61
    v_max_f32 v62, 0x358637bd, v62
    v_max_f32 v63, 0x358637bd, v63
    v_add_f32 v56, v56, v32
    v_add_f32 v57, v57, v33
    v_add_f32 v58, v58, v34
    v_add_f32 v59, v59, v35
    v_add_f32 v60, v60, v36
    v_add_f32 v61, v61, v37
    v_add_f32 v62, v62, v38
    v_add_f32 v63, v63, v39
    v_cvt_pk_bf16_f32 v44, v56, v57
    v_cvt_pk_bf16_f32 v45, v58, v59
    v_cvt_pk_bf16_f32 v46, v60, v61
    v_cvt_pk_bf16_f32 v47, v62, v63
    v_and_b32 v46, v28, v46
    v_and_b32 v47, v28, v47
    buffer_store_dwordx4 v[40:43], v1, s[36:39], s66 offen offset:0 sc1
    buffer_store_dwordx4 v[44:47], v1, s[36:39], s66 offen offset:1024 sc1
    s_nop 1
    v_mul_f32 v32, v64, v27
    v_mul_f32 v33, v65, v27
    v_mul_f32 v34, v66, v27
    v_mul_f32 v35, v67, v27
    v_mul_f32 v36, v68, v27
    v_mul_f32 v37, v69, v27
    v_mul_f32 v38, v70, v27
    v_mul_f32 v39, v71, v27
    v_exp_f32_e64 v32, v32 clamp
    v_fmaak_f32 v64, v64, v26, 0x358637bd
    v_exp_f32_e64 v33, v33 clamp
    v_fmaak_f32 v65, v65, v26, 0x358637bd
    v_exp_f32_e64 v34, v34 clamp
    v_fmaak_f32 v66, v66, v26, 0x358637bd
    v_exp_f32_e64 v35, v35 clamp
    v_fmaak_f32 v67, v67, v26, 0x358637bd
    v_exp_f32_e64 v36, v36 clamp
    v_fmaak_f32 v68, v68, v26, 0x358637bd
    v_exp_f32_e64 v37, v37 clamp
    v_fmaak_f32 v69, v69, v26, 0x358637bd
    v_exp_f32_e64 v38, v38 clamp
    v_fmaak_f32 v70, v70, v26, 0x358637bd
    v_exp_f32_e64 v39, v39 clamp
    v_fmaak_f32 v71, v71, v26, 0x358637bd
    v_max_f32 v64, 0x358637bd, v64
    v_max_f32 v65, 0x358637bd, v65
    v_max_f32 v66, 0x358637bd, v66
    v_max_f32 v67, 0x358637bd, v67
    v_max_f32 v68, 0x358637bd, v68
    v_max_f32 v69, 0x358637bd, v69
    v_max_f32 v70, 0x358637bd, v70
    v_max_f32 v71, 0x358637bd, v71
    v_add_f32 v64, v64, v32
    v_add_f32 v65, v65, v33
    v_add_f32 v66, v66, v34
    v_add_f32 v67, v67, v35
    v_add_f32 v68, v68, v36
    v_add_f32 v69, v69, v37
    v_add_f32 v70, v70, v38
    v_add_f32 v71, v71, v39
    v_cvt_pk_bf16_f32 v40, v64, v65
    v_cvt_pk_bf16_f32 v41, v66, v67
    v_cvt_pk_bf16_f32 v42, v68, v69
    v_cvt_pk_bf16_f32 v43, v70, v71
    v_mul_f32 v32, v72, v27
    v_mul_f32 v33, v73, v27
    v_mul_f32 v34, v74, v27
    v_mul_f32 v35, v75, v27
    v_mul_f32 v36, v76, v27
    v_mul_f32 v37, v77, v27
    v_mul_f32 v38, v78, v27
    v_mul_f32 v39, v79, v27
    v_exp_f32_e64 v32, v32 clamp
    v_fmaak_f32 v72, v72, v26, 0x358637bd
    v_exp_f32_e64 v33, v33 clamp
    v_fmaak_f32 v73, v73, v26, 0x358637bd
    v_exp_f32_e64 v34, v34 clamp
    v_fmaak_f32 v74, v74, v26, 0x358637bd
    v_exp_f32_e64 v35, v35 clamp
    v_fmaak_f32 v75, v75, v26, 0x358637bd
    v_exp_f32_e64 v36, v36 clamp
    v_fmaak_f32 v76, v76, v26, 0x358637bd
    v_exp_f32_e64 v37, v37 clamp
    v_fmaak_f32 v77, v77, v26, 0x358637bd
    v_exp_f32_e64 v38, v38 clamp
    v_fmaak_f32 v78, v78, v26, 0x358637bd
    v_exp_f32_e64 v39, v39 clamp
    v_fmaak_f32 v79, v79, v26, 0x358637bd
    v_max_f32 v72, 0x358637bd, v72
    v_max_f32 v73, 0x358637bd, v73
    v_max_f32 v74, 0x358637bd, v74
    v_max_f32 v75, 0x358637bd, v75
    v_max_f32 v76, 0x358637bd, v76
    v_max_f32 v77, 0x358637bd, v77
    v_max_f32 v78, 0x358637bd, v78
    v_max_f32 v79, 0x358637bd, v79
    v_add_f32 v72, v72, v32
    v_add_f32 v73, v73, v33
    v_add_f32 v74, v74, v34
    v_add_f32 v75, v75, v35
    v_add_f32 v76, v76, v36
    v_add_f32 v77, v77, v37
    v_add_f32 v78, v78, v38
    v_add_f32 v79, v79, v39
    v_cvt_pk_bf16_f32 v44, v72, v73
    v_cvt_pk_bf16_f32 v45, v74, v75
    v_cvt_pk_bf16_f32 v46, v76, v77
    v_cvt_pk_bf16_f32 v47, v78, v79
    v_and_b32 v46, v28, v46
    v_and_b32 v47, v28, v47
    buffer_store_dwordx4 v[40:43], v1, s[36:39], s66 offen offset:2048 sc1
    buffer_store_dwordx4 v[44:47], v1, s[36:39], s66 offen offset:3072 sc1
    s_nop 1
    v_mul_f32 v32, v80, v27
    v_mul_f32 v33, v81, v27
    v_mul_f32 v34, v82, v27
    v_mul_f32 v35, v83, v27
    v_mul_f32 v36, v84, v27
    v_mul_f32 v37, v85, v27
    v_mul_f32 v38, v86, v27
    v_mul_f32 v39, v87, v27
    v_exp_f32_e64 v32, v32 clamp
    v_fmaak_f32 v80, v80, v26, 0x358637bd
    v_exp_f32_e64 v33, v33 clamp
    v_fmaak_f32 v81, v81, v26, 0x358637bd
    v_exp_f32_e64 v34, v34 clamp
    v_fmaak_f32 v82, v82, v26, 0x358637bd
    v_exp_f32_e64 v35, v35 clamp
    v_fmaak_f32 v83, v83, v26, 0x358637bd
    v_exp_f32_e64 v36, v36 clamp
    v_fmaak_f32 v84, v84, v26, 0x358637bd
    v_exp_f32_e64 v37, v37 clamp
    v_fmaak_f32 v85, v85, v26, 0x358637bd
    v_exp_f32_e64 v38, v38 clamp
    v_fmaak_f32 v86, v86, v26, 0x358637bd
    v_exp_f32_e64 v39, v39 clamp
    v_fmaak_f32 v87, v87, v26, 0x358637bd
    v_max_f32 v80, 0x358637bd, v80
    v_max_f32 v81, 0x358637bd, v81
    v_max_f32 v82, 0x358637bd, v82
    v_max_f32 v83, 0x358637bd, v83
    v_max_f32 v84, 0x358637bd, v84
    v_max_f32 v85, 0x358637bd, v85
    v_max_f32 v86, 0x358637bd, v86
    v_max_f32 v87, 0x358637bd, v87
    v_add_f32 v80, v80, v32
    v_add_f32 v81, v81, v33
    v_add_f32 v82, v82, v34
    v_add_f32 v83, v83, v35
    v_add_f32 v84, v84, v36
    v_add_f32 v85, v85, v37
    v_add_f32 v86, v86, v38
    v_add_f32 v87, v87, v39
    v_cvt_pk_bf16_f32 v40, v80, v81
    v_cvt_pk_bf16_f32 v41, v82, v83
    v_cvt_pk_bf16_f32 v42, v84, v85
    v_cvt_pk_bf16_f32 v43, v86, v87
    v_mul_f32 v32, v88, v27
    v_mul_f32 v33, v89, v27
    v_mul_f32 v34, v90, v27
    v_mul_f32 v35, v91, v27
    v_mul_f32 v36, v92, v27
    v_mul_f32 v37, v93, v27
    v_mul_f32 v38, v94, v27
    v_mul_f32 v39, v95, v27
    v_exp_f32_e64 v32, v32 clamp
    v_fmaak_f32 v88, v88, v26, 0x358637bd
    v_exp_f32_e64 v33, v33 clamp
    v_fmaak_f32 v89, v89, v26, 0x358637bd
    v_exp_f32_e64 v34, v34 clamp
    v_fmaak_f32 v90, v90, v26, 0x358637bd
    v_exp_f32_e64 v35, v35 clamp
    v_fmaak_f32 v91, v91, v26, 0x358637bd
    v_exp_f32_e64 v36, v36 clamp
    v_fmaak_f32 v92, v92, v26, 0x358637bd
    v_exp_f32_e64 v37, v37 clamp
    v_fmaak_f32 v93, v93, v26, 0x358637bd
    v_exp_f32_e64 v38, v38 clamp
    v_fmaak_f32 v94, v94, v26, 0x358637bd
    v_exp_f32_e64 v39, v39 clamp
    v_fmaak_f32 v95, v95, v26, 0x358637bd
    v_max_f32 v88, 0x358637bd, v88
    v_max_f32 v89, 0x358637bd, v89
    v_max_f32 v90, 0x358637bd, v90
    v_max_f32 v91, 0x358637bd, v91
    v_max_f32 v92, 0x358637bd, v92
    v_max_f32 v93, 0x358637bd, v93
    v_max_f32 v94, 0x358637bd, v94
    v_max_f32 v95, 0x358637bd, v95
    v_add_f32 v88, v88, v32
    v_add_f32 v89, v89, v33
    v_add_f32 v90, v90, v34
    v_add_f32 v91, v91, v35
    v_add_f32 v92, v92, v36
    v_add_f32 v93, v93, v37
    v_add_f32 v94, v94, v38
    v_add_f32 v95, v95, v39
    v_cvt_pk_bf16_f32 v44, v88, v89
    v_cvt_pk_bf16_f32 v45, v90, v91
    v_cvt_pk_bf16_f32 v46, v92, v93
    v_cvt_pk_bf16_f32 v47, v94, v95
    v_and_b32 v46, v28, v46
    v_and_b32 v47, v28, v47
    s_add_u32 s66, s66, 4096
    buffer_store_dwordx4 v[40:43], v1, s[36:39], s66 offen offset:0 sc1
    buffer_store_dwordx4 v[44:47], v1, s[36:39], s66 offen offset:1024 sc1
    s_nop 1
    v_mul_f32 v32, v96, v27
    v_mul_f32 v33, v97, v27
    v_mul_f32 v34, v98, v27
    v_mul_f32 v35, v99, v27
    v_mul_f32 v36, v100, v27
    v_mul_f32 v37, v101, v27
    v_mul_f32 v38, v102, v27
    v_mul_f32 v39, v103, v27
    v_exp_f32_e64 v32, v32 clamp
    v_fmaak_f32 v96, v96, v26, 0x358637bd
    v_exp_f32_e64 v33, v33 clamp
    v_fmaak_f32 v97, v97, v26, 0x358637bd
    v_exp_f32_e64 v34, v34 clamp
    v_fmaak_f32 v98, v98, v26, 0x358637bd
    v_exp_f32_e64 v35, v35 clamp
    v_fmaak_f32 v99, v99, v26, 0x358637bd
    v_exp_f32_e64 v36, v36 clamp
    v_fmaak_f32 v100, v100, v26, 0x358637bd
    v_exp_f32_e64 v37, v37 clamp
    v_fmaak_f32 v101, v101, v26, 0x358637bd
    v_exp_f32_e64 v38, v38 clamp
    v_fmaak_f32 v102, v102, v26, 0x358637bd
    v_exp_f32_e64 v39, v39 clamp
    v_fmaak_f32 v103, v103, v26, 0x358637bd
    v_max_f32 v96, 0x358637bd, v96
    v_max_f32 v97, 0x358637bd, v97
    v_max_f32 v98, 0x358637bd, v98
    v_max_f32 v99, 0x358637bd, v99
    v_max_f32 v100, 0x358637bd, v100
    v_max_f32 v101, 0x358637bd, v101
    v_max_f32 v102, 0x358637bd, v102
    v_max_f32 v103, 0x358637bd, v103
    v_add_f32 v96, v96, v32
    v_add_f32 v97, v97, v33
    v_add_f32 v98, v98, v34
    v_add_f32 v99, v99, v35
    v_add_f32 v100, v100, v36
    v_add_f32 v101, v101, v37
    v_add_f32 v102, v102, v38
    v_add_f32 v103, v103, v39
    v_cvt_pk_bf16_f32 v40, v96, v97
    v_cvt_pk_bf16_f32 v41, v98, v99
    v_cvt_pk_bf16_f32 v42, v100, v101
    v_cvt_pk_bf16_f32 v43, v102, v103
    v_mul_f32 v32, v104, v27
    v_mul_f32 v33, v105, v27
    v_mul_f32 v34, v106, v27
    v_mul_f32 v35, v107, v27
    v_mul_f32 v36, v108, v27
    v_mul_f32 v37, v109, v27
    v_mul_f32 v38, v110, v27
    v_mul_f32 v39, v111, v27
    v_exp_f32_e64 v32, v32 clamp
    v_fmaak_f32 v104, v104, v26, 0x358637bd
    v_exp_f32_e64 v33, v33 clamp
    v_fmaak_f32 v105, v105, v26, 0x358637bd
    v_exp_f32_e64 v34, v34 clamp
    v_fmaak_f32 v106, v106, v26, 0x358637bd
    v_exp_f32_e64 v35, v35 clamp
    v_fmaak_f32 v107, v107, v26, 0x358637bd
    v_exp_f32_e64 v36, v36 clamp
    v_fmaak_f32 v108, v108, v26, 0x358637bd
    v_exp_f32_e64 v37, v37 clamp
    v_fmaak_f32 v109, v109, v26, 0x358637bd
    v_exp_f32_e64 v38, v38 clamp
    v_fmaak_f32 v110, v110, v26, 0x358637bd
    v_exp_f32_e64 v39, v39 clamp
    v_fmaak_f32 v111, v111, v26, 0x358637bd
    v_max_f32 v104, 0x358637bd, v104
    v_max_f32 v105, 0x358637bd, v105
    v_max_f32 v106, 0x358637bd, v106
    v_max_f32 v107, 0x358637bd, v107
    v_max_f32 v108, 0x358637bd, v108
    v_max_f32 v109, 0x358637bd, v109
    v_max_f32 v110, 0x358637bd, v110
    v_max_f32 v111, 0x358637bd, v111
    v_add_f32 v104, v104, v32
    v_add_f32 v105, v105, v33
    v_add_f32 v106, v106, v34
    v_add_f32 v107, v107, v35
    v_add_f32 v108, v108, v36
    v_add_f32 v109, v109, v37
    v_add_f32 v110, v110, v38
    v_add_f32 v111, v111, v39
    v_cvt_pk_bf16_f32 v44, v104, v105
    v_cvt_pk_bf16_f32 v45, v106, v107
    v_cvt_pk_bf16_f32 v46, v108, v109
    v_cvt_pk_bf16_f32 v47, v110, v111
    v_and_b32 v46, v28, v46
    v_and_b32 v47, v28, v47
    buffer_store_dwordx4 v[40:43], v1, s[36:39], s66 offen offset:2048 sc1
    buffer_store_dwordx4 v[44:47], v1, s[36:39], s66 offen offset:3072 sc1
    s_nop 1
    s_waitcnt lgkmcnt(4)
    v_mfma_f32_32x32x16_bf16 v[48:63], a[0:3], v[112:115], 0
    ds_read_b64_tr_b16 a[16:17], v12 offset:20480
    ds_read_b64_tr_b16 a[18:19], v12 offset:22528
    v_mfma_f32_32x32x16_bf16 v[64:79], a[4:7], v[112:115], 0
    ds_read_b64_tr_b16 a[20:21], v13 offset:20480
    ds_read_b64_tr_b16 a[22:23], v13 offset:22528
    s_waitcnt lgkmcnt(4)
    v_mfma_f32_32x32x16_bf16 v[80:95], a[8:11], v[112:115], 0
    ds_read_b64_tr_b16 a[24:25], v14 offset:20480
    ds_read_b64_tr_b16 a[26:27], v14 offset:22528
    v_mfma_f32_32x32x16_bf16 v[96:111], a[12:15], v[112:115], 0
    ds_read_b64_tr_b16 a[28:29], v15 offset:20480
    ds_read_b64_tr_b16 a[30:31], v15 offset:22528
    s_waitcnt lgkmcnt(4)
    v_mfma_f32_32x32x16_bf16 v[48:63], a[16:19], v[116:119], v[48:63]
    ds_read_b64_tr_b16 a[0:1], v12 offset:24576
    ds_read_b64_tr_b16 a[2:3], v12 offset:26624
    v_mfma_f32_32x32x16_bf16 v[64:79], a[20:23], v[116:119], v[64:79]
    ds_read_b64_tr_b16 a[4:5], v13 offset:24576
    ds_read_b64_tr_b16 a[6:7], v13 offset:26624
    s_waitcnt lgkmcnt(4)
    v_mfma_f32_32x32x16_bf16 v[80:95], a[24:27], v[116:119], v[80:95]
    ds_read_b64_tr_b16 a[8:9], v14 offset:24576
    ds_read_b64_tr_b16 a[10:11], v14 offset:26624
    v_mfma_f32_32x32x16_bf16 v[96:111], a[28:31], v[116:119], v[96:111]
    ds_read_b64_tr_b16 a[12:13], v15 offset:24576
    ds_read_b64_tr_b16 a[14:15], v15 offset:26624
    s_waitcnt lgkmcnt(4)
    v_mfma_f32_32x32x16_bf16 v[48:63], a[0:3], v[120:123], v[48:63]
    ds_read_b64_tr_b16 a[16:17], v12 offset:28672
    ds_read_b64_tr_b16 a[18:19], v12 offset:30720
    v_mfma_f32_32x32x16_bf16 v[64:79], a[4:7], v[120:123], v[64:79]
    ds_read_b64_tr_b16 a[20:21], v13 offset:28672
    ds_read_b64_tr_b16 a[22:23], v13 offset:30720
    s_waitcnt lgkmcnt(4)
    v_mfma_f32_32x32x16_bf16 v[80:95], a[8:11], v[120:123], v[80:95]
    ds_read_b64_tr_b16 a[24:25], v14 offset:28672
    ds_read_b64_tr_b16 a[26:27], v14 offset:30720
    v_mfma_f32_32x32x16_bf16 v[96:111], a[12:15], v[120:123], v[96:111]
    ds_read_b64_tr_b16 a[28:29], v15 offset:28672
    ds_read_b64_tr_b16 a[30:31], v15 offset:30720
    s_waitcnt lgkmcnt(4)
    v_mfma_f32_32x32x16_bf16 v[48:63], a[16:19], v[124:127], v[48:63]
    s_barrier
    v_mfma_f32_32x32x16_bf16 v[64:79], a[20:23], v[124:127], v[64:79]
    ds_read_b64_tr_b16 a[0:1], v12 offset:32768
    ds_read_b64_tr_b16 a[2:3], v12 offset:34816
    ds_read_b64_tr_b16 a[4:5], v13 offset:32768
    ds_read_b64_tr_b16 a[6:7], v13 offset:34816
    s_waitcnt lgkmcnt(4)
    v_mfma_f32_32x32x16_bf16 v[80:95], a[24:27], v[124:127], v[80:95]
    ds_read_b64_tr_b16 a[8:9], v14 offset:32768
    ds_read_b64_tr_b16 a[10:11], v14 offset:34816
    v_mfma_f32_32x32x16_bf16 v[96:111], a[28:31], v[124:127], v[96:111]
    ds_read_b64_tr_b16 a[12:13], v15 offset:32768
    ds_read_b64_tr_b16 a[14:15], v15 offset:34816
    s_waitcnt lgkmcnt(4)
    v_mfma_f32_32x32x16_bf16 v[48:63], a[0:3], v[128:131], v[48:63]
    ds_read_b64_tr_b16 a[16:17], v12 offset:36864
    ds_read_b64_tr_b16 a[18:19], v12 offset:38912
    s_lshl_b32 s64, s57, 1
    s_add_u32 s64, s64, s54
    s_lshl_b32 s64, s64, 5
    v_mfma_f32_32x32x16_bf16 v[64:79], a[4:7], v[128:131], v[64:79]
    ds_read_b64_tr_b16 a[20:21], v13 offset:36864
    ds_read_b64_tr_b16 a[22:23], v13 offset:38912
    s_add_u32 s64, s64, s55
    s_lshl_b32 s64, s64, 2
    s_waitcnt lgkmcnt(4)
    v_mfma_f32_32x32x16_bf16 v[80:95], a[8:11], v[128:131], v[80:95]
    ds_read_b64_tr_b16 a[24:25], v14 offset:36864
    ds_read_b64_tr_b16 a[26:27], v14 offset:38912
    s_add_u32 s64, s64, 0xa14000
    s_waitcnt vmcnt(0)
    buffer_store_dword v30, off, s[36:39], s64 offset:0 sc1
    v_mfma_f32_32x32x16_bf16 v[96:111], a[12:15], v[128:131], v[96:111]
    ds_read_b64_tr_b16 a[28:29], v15 offset:36864
    ds_read_b64_tr_b16 a[30:31], v15 offset:38912
    s_waitcnt lgkmcnt(4)
    v_mfma_f32_32x32x16_bf16 v[48:63], a[16:19], v[132:135], v[48:63]
    ds_read_b64_tr_b16 a[0:1], v12 offset:40960
    ds_read_b64_tr_b16 a[2:3], v12 offset:43008
    v_mfma_f32_32x32x16_bf16 v[64:79], a[20:23], v[132:135], v[64:79]
    ds_read_b64_tr_b16 a[4:5], v13 offset:40960
    ds_read_b64_tr_b16 a[6:7], v13 offset:43008
    s_waitcnt lgkmcnt(4)
    v_mfma_f32_32x32x16_bf16 v[80:95], a[24:27], v[132:135], v[80:95]
    ds_read_b64_tr_b16 a[8:9], v14 offset:40960
    ds_read_b64_tr_b16 a[10:11], v14 offset:43008
    v_mfma_f32_32x32x16_bf16 v[96:111], a[28:31], v[132:135], v[96:111]
    ds_read_b64_tr_b16 a[12:13], v15 offset:40960
    ds_read_b64_tr_b16 a[14:15], v15 offset:43008
    s_waitcnt lgkmcnt(4)
    v_mfma_f32_32x32x16_bf16 v[48:63], a[0:3], v[136:139], v[48:63]
    ds_read_b64_tr_b16 a[16:17], v12 offset:45056
    ds_read_b64_tr_b16 a[18:19], v12 offset:47104
    v_mfma_f32_32x32x16_bf16 v[64:79], a[4:7], v[136:139], v[64:79]
    ds_read_b64_tr_b16 a[20:21], v13 offset:45056
    ds_read_b64_tr_b16 a[22:23], v13 offset:47104
    s_waitcnt lgkmcnt(4)
    v_mfma_f32_32x32x16_bf16 v[80:95], a[8:11], v[136:139], v[80:95]
    ds_read_b64_tr_b16 a[24:25], v14 offset:45056
    ds_read_b64_tr_b16 a[26:27], v14 offset:47104
    v_mfma_f32_32x32x16_bf16 v[96:111], a[12:15], v[136:139], v[96:111]
    ds_read_b64_tr_b16 a[28:29], v15 offset:45056
    ds_read_b64_tr_b16 a[30:31], v15 offset:47104
    s_waitcnt lgkmcnt(4)
    v_mfma_f32_32x32x16_bf16 v[48:63], a[16:19], v[140:143], v[48:63]
    s_barrier
    v_mfma_f32_32x32x16_bf16 v[64:79], a[20:23], v[140:143], v[64:79]
    ds_read_b64_tr_b16 a[0:1], v16 offset:0
    ds_read_b64_tr_b16 a[2:3], v16 offset:2048
    ds_read_b64_tr_b16 a[4:5], v17 offset:0
    ds_read_b64_tr_b16 a[6:7], v17 offset:2048
    s_waitcnt lgkmcnt(4)
    v_mfma_f32_32x32x16_bf16 v[80:95], a[24:27], v[140:143], v[80:95]
    ds_read_b64_tr_b16 a[8:9], v18 offset:0
    ds_read_b64_tr_b16 a[10:11], v18 offset:2048
    v_mfma_f32_32x32x16_bf16 v[96:111], a[28:31], v[140:143], v[96:111]
    ds_read_b64_tr_b16 a[12:13], v19 offset:0
    ds_read_b64_tr_b16 a[14:15], v19 offset:2048
    s_waitcnt lgkmcnt(4)
    v_mfma_f32_32x32x16_bf16 v[48:63], a[0:3], v[144:147], v[48:63]
    ds_read_b64_tr_b16 a[16:17], v16 offset:4096
    ds_read_b64_tr_b16 a[18:19], v16 offset:6144
    v_mfma_f32_32x32x16_bf16 v[64:79], a[4:7], v[144:147], v[64:79]
    ds_read_b64_tr_b16 a[20:21], v17 offset:4096
    ds_read_b64_tr_b16 a[22:23], v17 offset:6144
    s_waitcnt lgkmcnt(4)
    v_mfma_f32_32x32x16_bf16 v[80:95], a[8:11], v[144:147], v[80:95]
    ds_read_b64_tr_b16 a[24:25], v18 offset:4096
    ds_read_b64_tr_b16 a[26:27], v18 offset:6144
    v_mfma_f32_32x32x16_bf16 v[96:111], a[12:15], v[144:147], v[96:111]
    ds_read_b64_tr_b16 a[28:29], v19 offset:4096
    ds_read_b64_tr_b16 a[30:31], v19 offset:6144
    s_waitcnt lgkmcnt(4)
    v_mfma_f32_32x32x16_bf16 v[48:63], a[16:19], v[148:151], v[48:63]
    ds_read_b64_tr_b16 a[0:1], v16 offset:8192
    ds_read_b64_tr_b16 a[2:3], v16 offset:10240
    v_mfma_f32_32x32x16_bf16 v[64:79], a[20:23], v[148:151], v[64:79]
    ds_read_b64_tr_b16 a[4:5], v17 offset:8192
    ds_read_b64_tr_b16 a[6:7], v17 offset:10240
    s_waitcnt lgkmcnt(4)
    v_mfma_f32_32x32x16_bf16 v[80:95], a[24:27], v[148:151], v[80:95]
    ds_read_b64_tr_b16 a[8:9], v18 offset:8192
    ds_read_b64_tr_b16 a[10:11], v18 offset:10240
    v_mfma_f32_32x32x16_bf16 v[96:111], a[28:31], v[148:151], v[96:111]
    ds_read_b64_tr_b16 a[12:13], v19 offset:8192
    ds_read_b64_tr_b16 a[14:15], v19 offset:10240
    s_waitcnt lgkmcnt(4)
    v_mfma_f32_32x32x16_bf16 v[48:63], a[0:3], v[152:155], v[48:63]
    ds_read_b64_tr_b16 a[16:17], v16 offset:12288
    ds_read_b64_tr_b16 a[18:19], v16 offset:14336
    v_mfma_f32_32x32x16_bf16 v[64:79], a[4:7], v[152:155], v[64:79]
    ds_read_b64_tr_b16 a[20:21], v17 offset:12288
    ds_read_b64_tr_b16 a[22:23], v17 offset:14336
    s_waitcnt lgkmcnt(4)
    v_mfma_f32_32x32x16_bf16 v[80:95], a[8:11], v[152:155], v[80:95]
    ds_read_b64_tr_b16 a[24:25], v18 offset:12288
    ds_read_b64_tr_b16 a[26:27], v18 offset:14336
    v_mfma_f32_32x32x16_bf16 v[96:111], a[12:15], v[152:155], v[96:111]
    ds_read_b64_tr_b16 a[28:29], v19 offset:12288
    ds_read_b64_tr_b16 a[30:31], v19 offset:14336
    s_waitcnt lgkmcnt(4)
    v_mfma_f32_32x32x16_bf16 v[48:63], a[16:19], v[156:159], v[48:63]
    s_barrier
    v_mfma_f32_32x32x16_bf16 v[64:79], a[20:23], v[156:159], v[64:79]
    ds_read_b64_tr_b16 a[0:1], v16 offset:16384
    ds_read_b64_tr_b16 a[2:3], v16 offset:18432
    ds_read_b64_tr_b16 a[4:5], v17 offset:16384
    ds_read_b64_tr_b16 a[6:7], v17 offset:18432
    s_waitcnt lgkmcnt(4)
    v_mfma_f32_32x32x16_bf16 v[80:95], a[24:27], v[156:159], v[80:95]
    ds_read_b64_tr_b16 a[8:9], v18 offset:16384
    ds_read_b64_tr_b16 a[10:11], v18 offset:18432
    v_mfma_f32_32x32x16_bf16 v[96:111], a[28:31], v[156:159], v[96:111]
    ds_read_b64_tr_b16 a[12:13], v19 offset:16384
    ds_read_b64_tr_b16 a[14:15], v19 offset:18432
    s_waitcnt lgkmcnt(4)
    v_mfma_f32_32x32x16_bf16 v[48:63], a[0:3], v[160:163], v[48:63]
    ds_read_b64_tr_b16 a[16:17], v16 offset:20480
    ds_read_b64_tr_b16 a[18:19], v16 offset:22528
    v_mfma_f32_32x32x16_bf16 v[64:79], a[4:7], v[160:163], v[64:79]
    ds_read_b64_tr_b16 a[20:21], v17 offset:20480
    ds_read_b64_tr_b16 a[22:23], v17 offset:22528
    s_waitcnt lgkmcnt(4)
    v_mfma_f32_32x32x16_bf16 v[80:95], a[8:11], v[160:163], v[80:95]
    ds_read_b64_tr_b16 a[24:25], v18 offset:20480
    ds_read_b64_tr_b16 a[26:27], v18 offset:22528
    v_mfma_f32_32x32x16_bf16 v[96:111], a[12:15], v[160:163], v[96:111]
    ds_read_b64_tr_b16 a[28:29], v19 offset:20480
    ds_read_b64_tr_b16 a[30:31], v19 offset:22528
    s_waitcnt lgkmcnt(4)
    v_mfma_f32_32x32x16_bf16 v[48:63], a[16:19], v[164:167], v[48:63]
    ds_read_b64_tr_b16 a[0:1], v16 offset:24576
    ds_read_b64_tr_b16 a[2:3], v16 offset:26624
    v_mfma_f32_32x32x16_bf16 v[64:79], a[20:23], v[164:167], v[64:79]
    ds_read_b64_tr_b16 a[4:5], v17 offset:24576
    ds_read_b64_tr_b16 a[6:7], v17 offset:26624
    s_waitcnt lgkmcnt(4)
    v_mfma_f32_32x32x16_bf16 v[80:95], a[24:27], v[164:167], v[80:95]
    ds_read_b64_tr_b16 a[8:9], v18 offset:24576
    ds_read_b64_tr_b16 a[10:11], v18 offset:26624
    v_mfma_f32_32x32x16_bf16 v[96:111], a[28:31], v[164:167], v[96:111]
    ds_read_b64_tr_b16 a[12:13], v19 offset:24576
    ds_read_b64_tr_b16 a[14:15], v19 offset:26624
    s_waitcnt lgkmcnt(4)
    v_mfma_f32_32x32x16_bf16 v[48:63], a[0:3], v[168:171], v[48:63]
    ds_read_b64_tr_b16 a[16:17], v16 offset:28672
    ds_read_b64_tr_b16 a[18:19], v16 offset:30720
    v_mfma_f32_32x32x16_bf16 v[64:79], a[4:7], v[168:171], v[64:79]
    ds_read_b64_tr_b16 a[20:21], v17 offset:28672
    ds_read_b64_tr_b16 a[22:23], v17 offset:30720
    s_waitcnt lgkmcnt(4)
    v_mfma_f32_32x32x16_bf16 v[80:95], a[8:11], v[168:171], v[80:95]
    ds_read_b64_tr_b16 a[24:25], v18 offset:28672
    ds_read_b64_tr_b16 a[26:27], v18 offset:30720
    v_mfma_f32_32x32x16_bf16 v[96:111], a[12:15], v[168:171], v[96:111]
    ds_read_b64_tr_b16 a[28:29], v19 offset:28672
    ds_read_b64_tr_b16 a[30:31], v19 offset:30720
    s_waitcnt lgkmcnt(4)
    v_mfma_f32_32x32x16_bf16 v[48:63], a[16:19], v[172:175], v[48:63]
    s_barrier
    v_mfma_f32_32x32x16_bf16 v[64:79], a[20:23], v[172:175], v[64:79]
    ds_read_b64_tr_b16 a[0:1], v16 offset:32768
    ds_read_b64_tr_b16 a[2:3], v16 offset:34816
    ds_read_b64_tr_b16 a[4:5], v17 offset:32768
    ds_read_b64_tr_b16 a[6:7], v17 offset:34816
    s_waitcnt lgkmcnt(4)
    v_mfma_f32_32x32x16_bf16 v[80:95], a[24:27], v[172:175], v[80:95]
    ds_read_b64_tr_b16 a[8:9], v18 offset:32768
    ds_read_b64_tr_b16 a[10:11], v18 offset:34816
    v_mfma_f32_32x32x16_bf16 v[96:111], a[28:31], v[172:175], v[96:111]
    ds_read_b64_tr_b16 a[12:13], v19 offset:32768
    ds_read_b64_tr_b16 a[14:15], v19 offset:34816
    s_waitcnt lgkmcnt(4)
    v_mfma_f32_32x32x16_bf16 v[48:63], a[0:3], v[176:179], v[48:63]
    ds_read_b64_tr_b16 a[16:17], v16 offset:36864
    ds_read_b64_tr_b16 a[18:19], v16 offset:38912
    v_mfma_f32_32x32x16_bf16 v[64:79], a[4:7], v[176:179], v[64:79]
    ds_read_b64_tr_b16 a[20:21], v17 offset:36864
    ds_read_b64_tr_b16 a[22:23], v17 offset:38912
    s_waitcnt lgkmcnt(4)
    v_mfma_f32_32x32x16_bf16 v[80:95], a[8:11], v[176:179], v[80:95]
    ds_read_b64_tr_b16 a[24:25], v18 offset:36864
    ds_read_b64_tr_b16 a[26:27], v18 offset:38912
    v_mfma_f32_32x32x16_bf16 v[96:111], a[12:15], v[176:179], v[96:111]
    ds_read_b64_tr_b16 a[28:29], v19 offset:36864
    ds_read_b64_tr_b16 a[30:31], v19 offset:38912
    s_waitcnt lgkmcnt(4)
    v_mfma_f32_32x32x16_bf16 v[48:63], a[16:19], v[180:183], v[48:63]
    ds_read_b64_tr_b16 a[0:1], v16 offset:40960
    ds_read_b64_tr_b16 a[2:3], v16 offset:43008
    v_mfma_f32_32x32x16_bf16 v[64:79], a[20:23], v[180:183], v[64:79]
    ds_read_b64_tr_b16 a[4:5], v17 offset:40960
    ds_read_b64_tr_b16 a[6:7], v17 offset:43008
    s_waitcnt lgkmcnt(4)
    v_mfma_f32_32x32x16_bf16 v[80:95], a[24:27], v[180:183], v[80:95]
    ds_read_b64_tr_b16 a[8:9], v18 offset:40960
    ds_read_b64_tr_b16 a[10:11], v18 offset:43008
    v_mfma_f32_32x32x16_bf16 v[96:111], a[28:31], v[180:183], v[96:111]
    ds_read_b64_tr_b16 a[12:13], v19 offset:40960
    ds_read_b64_tr_b16 a[14:15], v19 offset:43008
    s_waitcnt lgkmcnt(4)
    v_mfma_f32_32x32x16_bf16 v[48:63], a[0:3], v[184:187], v[48:63]
    ds_read_b64_tr_b16 a[16:17], v16 offset:45056
    ds_read_b64_tr_b16 a[18:19], v16 offset:47104
    v_mfma_f32_32x32x16_bf16 v[64:79], a[4:7], v[184:187], v[64:79]
    ds_read_b64_tr_b16 a[20:21], v17 offset:45056
    ds_read_b64_tr_b16 a[22:23], v17 offset:47104
    s_waitcnt lgkmcnt(4)
    v_mfma_f32_32x32x16_bf16 v[80:95], a[8:11], v[184:187], v[80:95]
    ds_read_b64_tr_b16 a[24:25], v18 offset:45056
    ds_read_b64_tr_b16 a[26:27], v18 offset:47104
    v_mfma_f32_32x32x16_bf16 v[96:111], a[12:15], v[184:187], v[96:111]
    ds_read_b64_tr_b16 a[28:29], v19 offset:45056
    ds_read_b64_tr_b16 a[30:31], v19 offset:47104
    s_waitcnt lgkmcnt(4)
    v_mfma_f32_32x32x16_bf16 v[48:63], a[16:19], v[188:191], v[48:63]
    s_barrier
    v_mfma_f32_32x32x16_bf16 v[64:79], a[20:23], v[188:191], v[64:79]
    ds_read_b64_tr_b16 a[0:1], v16 offset:49152
    ds_read_b64_tr_b16 a[2:3], v16 offset:51200
    ds_read_b64_tr_b16 a[4:5], v17 offset:49152
    ds_read_b64_tr_b16 a[6:7], v17 offset:51200
    s_waitcnt lgkmcnt(4)
    v_mfma_f32_32x32x16_bf16 v[80:95], a[24:27], v[188:191], v[80:95]
    ds_read_b64_tr_b16 a[8:9], v18 offset:49152
    ds_read_b64_tr_b16 a[10:11], v18 offset:51200
    v_mfma_f32_32x32x16_bf16 v[96:111], a[28:31], v[188:191], v[96:111]
    ds_read_b64_tr_b16 a[12:13], v19 offset:49152
    ds_read_b64_tr_b16 a[14:15], v19 offset:51200
    s_waitcnt lgkmcnt(4)
    v_mfma_f32_32x32x16_bf16 v[48:63], a[0:3], v[192:195], v[48:63]
    ds_read_b64_tr_b16 a[16:17], v16 offset:53248
    ds_read_b64_tr_b16 a[18:19], v16 offset:55296
    v_mfma_f32_32x32x16_bf16 v[64:79], a[4:7], v[192:195], v[64:79]
    ds_read_b64_tr_b16 a[20:21], v17 offset:53248
    ds_read_b64_tr_b16 a[22:23], v17 offset:55296
    s_waitcnt lgkmcnt(4)
    v_mfma_f32_32x32x16_bf16 v[80:95], a[8:11], v[192:195], v[80:95]
    ds_read_b64_tr_b16 a[24:25], v18 offset:53248
    ds_read_b64_tr_b16 a[26:27], v18 offset:55296
    v_mfma_f32_32x32x16_bf16 v[96:111], a[12:15], v[192:195], v[96:111]
    ds_read_b64_tr_b16 a[28:29], v19 offset:53248
    ds_read_b64_tr_b16 a[30:31], v19 offset:55296
    s_waitcnt lgkmcnt(4)
    v_mfma_f32_32x32x16_bf16 v[48:63], a[16:19], v[196:199], v[48:63]
    ds_read_b64_tr_b16 a[0:1], v16 offset:57344
    ds_read_b64_tr_b16 a[2:3], v16 offset:59392
    v_mfma_f32_32x32x16_bf16 v[64:79], a[20:23], v[196:199], v[64:79]
    ds_read_b64_tr_b16 a[4:5], v17 offset:57344
    ds_read_b64_tr_b16 a[6:7], v17 offset:59392
    s_waitcnt lgkmcnt(4)
    v_mfma_f32_32x32x16_bf16 v[80:95], a[24:27], v[196:199], v[80:95]
    ds_read_b64_tr_b16 a[8:9], v18 offset:57344
    ds_read_b64_tr_b16 a[10:11], v18 offset:59392
    v_mfma_f32_32x32x16_bf16 v[96:111], a[28:31], v[196:199], v[96:111]
    ds_read_b64_tr_b16 a[12:13], v19 offset:57344
    ds_read_b64_tr_b16 a[14:15], v19 offset:59392
    s_waitcnt lgkmcnt(4)
    v_mfma_f32_32x32x16_bf16 v[48:63], a[0:3], v[200:203], v[48:63]
    ds_read_b64_tr_b16 a[16:17], v16 offset:61440
    ds_read_b64_tr_b16 a[18:19], v16 offset:63488
    v_mfma_f32_32x32x16_bf16 v[64:79], a[4:7], v[200:203], v[64:79]
    ds_read_b64_tr_b16 a[20:21], v17 offset:61440
    ds_read_b64_tr_b16 a[22:23], v17 offset:63488
    s_waitcnt lgkmcnt(4)
    v_mfma_f32_32x32x16_bf16 v[80:95], a[8:11], v[200:203], v[80:95]
    ds_read_b64_tr_b16 a[24:25], v18 offset:61440
    ds_read_b64_tr_b16 a[26:27], v18 offset:63488
    v_mfma_f32_32x32x16_bf16 v[96:111], a[12:15], v[200:203], v[96:111]
    ds_read_b64_tr_b16 a[28:29], v19 offset:61440
    ds_read_b64_tr_b16 a[30:31], v19 offset:63488
    s_waitcnt lgkmcnt(4)
    v_mfma_f32_32x32x16_bf16 v[48:63], a[16:19], v[204:207], v[48:63]
    s_barrier
    v_mfma_f32_32x32x16_bf16 v[64:79], a[20:23], v[204:207], v[64:79]
    ds_read_b64_tr_b16 a[0:1], v20 offset:0
    ds_read_b64_tr_b16 a[2:3], v20 offset:2048
    ds_read_b64_tr_b16 a[4:5], v21 offset:0
    ds_read_b64_tr_b16 a[6:7], v21 offset:2048
    s_waitcnt lgkmcnt(4)
    v_mfma_f32_32x32x16_bf16 v[80:95], a[24:27], v[204:207], v[80:95]
    ds_read_b64_tr_b16 a[8:9], v22 offset:0
    ds_read_b64_tr_b16 a[10:11], v22 offset:2048
    v_mfma_f32_32x32x16_bf16 v[96:111], a[28:31], v[204:207], v[96:111]
    ds_read_b64_tr_b16 a[12:13], v23 offset:0
    ds_read_b64_tr_b16 a[14:15], v23 offset:2048
    s_waitcnt lgkmcnt(4)
    v_mfma_f32_32x32x16_bf16 v[48:63], a[0:3], v[208:211], v[48:63]
    ds_read_b64_tr_b16 a[16:17], v20 offset:4096
    ds_read_b64_tr_b16 a[18:19], v20 offset:6144
    v_mfma_f32_32x32x16_bf16 v[64:79], a[4:7], v[208:211], v[64:79]
    ds_read_b64_tr_b16 a[20:21], v21 offset:4096
    ds_read_b64_tr_b16 a[22:23], v21 offset:6144
    s_waitcnt lgkmcnt(4)
    v_mfma_f32_32x32x16_bf16 v[80:95], a[8:11], v[208:211], v[80:95]
    ds_read_b64_tr_b16 a[24:25], v22 offset:4096
    ds_read_b64_tr_b16 a[26:27], v22 offset:6144
    v_mfma_f32_32x32x16_bf16 v[96:111], a[12:15], v[208:211], v[96:111]
    ds_read_b64_tr_b16 a[28:29], v23 offset:4096
    ds_read_b64_tr_b16 a[30:31], v23 offset:6144
    s_waitcnt lgkmcnt(4)
    v_mfma_f32_32x32x16_bf16 v[48:63], a[16:19], v[212:215], v[48:63]
    ds_read_b64_tr_b16 a[0:1], v20 offset:8192
    ds_read_b64_tr_b16 a[2:3], v20 offset:10240
    v_mfma_f32_32x32x16_bf16 v[64:79], a[20:23], v[212:215], v[64:79]
    ds_read_b64_tr_b16 a[4:5], v21 offset:8192
    ds_read_b64_tr_b16 a[6:7], v21 offset:10240
    s_waitcnt lgkmcnt(4)
    v_mfma_f32_32x32x16_bf16 v[80:95], a[24:27], v[212:215], v[80:95]
    ds_read_b64_tr_b16 a[8:9], v22 offset:8192
    ds_read_b64_tr_b16 a[10:11], v22 offset:10240
    v_mfma_f32_32x32x16_bf16 v[96:111], a[28:31], v[212:215], v[96:111]
    ds_read_b64_tr_b16 a[12:13], v23 offset:8192
    ds_read_b64_tr_b16 a[14:15], v23 offset:10240
    s_waitcnt lgkmcnt(4)
    v_mfma_f32_32x32x16_bf16 v[48:63], a[0:3], v[216:219], v[48:63]
    ds_read_b64_tr_b16 a[16:17], v20 offset:12288
    ds_read_b64_tr_b16 a[18:19], v20 offset:14336
    v_mfma_f32_32x32x16_bf16 v[64:79], a[4:7], v[216:219], v[64:79]
    ds_read_b64_tr_b16 a[20:21], v21 offset:12288
    ds_read_b64_tr_b16 a[22:23], v21 offset:14336
    s_waitcnt lgkmcnt(4)
    v_mfma_f32_32x32x16_bf16 v[80:95], a[8:11], v[216:219], v[80:95]
    ds_read_b64_tr_b16 a[24:25], v22 offset:12288
    ds_read_b64_tr_b16 a[26:27], v22 offset:14336
    v_mfma_f32_32x32x16_bf16 v[96:111], a[12:15], v[216:219], v[96:111]
    ds_read_b64_tr_b16 a[28:29], v23 offset:12288
    ds_read_b64_tr_b16 a[30:31], v23 offset:14336
    s_waitcnt lgkmcnt(4)
    v_mfma_f32_32x32x16_bf16 v[48:63], a[16:19], v[220:223], v[48:63]
    v_mfma_f32_32x32x16_bf16 v[64:79], a[20:23], v[220:223], v[64:79]
    s_waitcnt lgkmcnt(0)
    v_mfma_f32_32x32x16_bf16 v[80:95], a[24:27], v[220:223], v[80:95]
    v_mfma_f32_32x32x16_bf16 v[96:111], a[28:31], v[220:223], v[96:111]
    s_lshl_b32 s66, s57, 15
    s_lshl_b32 s64, s54, 14
    s_add_u32 s66, s66, s64
    s_add_u32 s66, s66, 0x702000
    s_nop 3
    v_mul_f32 v32, v48, v27
    v_mul_f32 v33, v49, v27
    v_mul_f32 v34, v50, v27
    v_mul_f32 v35, v51, v27
    v_mul_f32 v36, v52, v27
    v_mul_f32 v37, v53, v27
    v_mul_f32 v38, v54, v27
    v_mul_f32 v39, v55, v27
    v_exp_f32_e64 v32, v32 clamp
    v_fmaak_f32 v48, v48, v26, 0x358637bd
    v_exp_f32_e64 v33, v33 clamp
    v_fmaak_f32 v49, v49, v26, 0x358637bd
    v_exp_f32_e64 v34, v34 clamp
    v_fmaak_f32 v50, v50, v26, 0x358637bd
    v_exp_f32_e64 v35, v35 clamp
    v_fmaak_f32 v51, v51, v26, 0x358637bd
    v_exp_f32_e64 v36, v36 clamp
    v_fmaak_f32 v52, v52, v26, 0x358637bd
    v_exp_f32_e64 v37, v37 clamp
    v_fmaak_f32 v53, v53, v26, 0x358637bd
    v_exp_f32_e64 v38, v38 clamp
    v_fmaak_f32 v54, v54, v26, 0x358637bd
    v_exp_f32_e64 v39, v39 clamp
    v_fmaak_f32 v55, v55, v26, 0x358637bd
    v_max_f32 v48, 0x358637bd, v48
    v_max_f32 v49, 0x358637bd, v49
    v_max_f32 v50, 0x358637bd, v50
    v_max_f32 v51, 0x358637bd, v51
    v_max_f32 v52, 0x358637bd, v52
    v_max_f32 v53, 0x358637bd, v53
    v_max_f32 v54, 0x358637bd, v54
    v_max_f32 v55, 0x358637bd, v55
    v_add_f32 v48, v48, v32
    v_add_f32 v49, v49, v33
    v_add_f32 v50, v50, v34
    v_add_f32 v51, v51, v35
    v_add_f32 v52, v52, v36
    v_add_f32 v53, v53, v37
    v_add_f32 v54, v54, v38
    v_add_f32 v55, v55, v39
    v_cvt_pk_bf16_f32 v40, v48, v49
    v_cvt_pk_bf16_f32 v41, v50, v51
    v_cvt_pk_bf16_f32 v42, v52, v53
    v_cvt_pk_bf16_f32 v43, v54, v55
    v_mul_f32 v32, v56, v27
    v_mul_f32 v33, v57, v27
    v_mul_f32 v34, v58, v27
    v_mul_f32 v35, v59, v27
    v_mul_f32 v36, v60, v27
    v_mul_f32 v37, v61, v27
    v_mul_f32 v38, v62, v27
    v_mul_f32 v39, v63, v27
    v_exp_f32_e64 v32, v32 clamp
    v_fmaak_f32 v56, v56, v26, 0x358637bd
    v_exp_f32_e64 v33, v33 clamp
    v_fmaak_f32 v57, v57, v26, 0x358637bd
    v_exp_f32_e64 v34, v34 clamp
    v_fmaak_f32 v58, v58, v26, 0x358637bd
    v_exp_f32_e64 v35, v35 clamp
    v_fmaak_f32 v59, v59, v26, 0x358637bd
    v_exp_f32_e64 v36, v36 clamp
    v_fmaak_f32 v60, v60, v26, 0x358637bd
    v_exp_f32_e64 v37, v37 clamp
    v_fmaak_f32 v61, v61, v26, 0x358637bd
    v_exp_f32_e64 v38, v38 clamp
    v_fmaak_f32 v62, v62, v26, 0x358637bd
    v_exp_f32_e64 v39, v39 clamp
    v_fmaak_f32 v63, v63, v26, 0x358637bd
    v_max_f32 v56, 0x358637bd, v56
    v_max_f32 v57, 0x358637bd, v57
    v_max_f32 v58, 0x358637bd, v58
    v_max_f32 v59, 0x358637bd, v59
    v_max_f32 v60, 0x358637bd, v60
    v_max_f32 v61, 0x358637bd, v61
    v_max_f32 v62, 0x358637bd, v62
    v_max_f32 v63, 0x358637bd, v63
    v_add_f32 v56, v56, v32
    v_add_f32 v57, v57, v33
    v_add_f32 v58, v58, v34
    v_add_f32 v59, v59, v35
    v_add_f32 v60, v60, v36
    v_add_f32 v61, v61, v37
    v_add_f32 v62, v62, v38
    v_add_f32 v63, v63, v39
    v_cvt_pk_bf16_f32 v44, v56, v57
    v_cvt_pk_bf16_f32 v45, v58, v59
    v_cvt_pk_bf16_f32 v46, v60, v61
    v_cvt_pk_bf16_f32 v47, v62, v63
    v_and_b32 v46, v28, v46
    v_and_b32 v47, v28, v47
    buffer_store_dwordx4 v[40:43], v1, s[36:39], s66 offen offset:0 sc1
    buffer_store_dwordx4 v[44:47], v1, s[36:39], s66 offen offset:1024 sc1
    s_nop 1
    v_mul_f32 v32, v64, v27
    v_mul_f32 v33, v65, v27
    v_mul_f32 v34, v66, v27
    v_mul_f32 v35, v67, v27
    v_mul_f32 v36, v68, v27
    v_mul_f32 v37, v69, v27
    v_mul_f32 v38, v70, v27
    v_mul_f32 v39, v71, v27
    v_exp_f32_e64 v32, v32 clamp
    v_fmaak_f32 v64, v64, v26, 0x358637bd
    v_exp_f32_e64 v33, v33 clamp
    v_fmaak_f32 v65, v65, v26, 0x358637bd
    v_exp_f32_e64 v34, v34 clamp
    v_fmaak_f32 v66, v66, v26, 0x358637bd
    v_exp_f32_e64 v35, v35 clamp
    v_fmaak_f32 v67, v67, v26, 0x358637bd
    v_exp_f32_e64 v36, v36 clamp
    v_fmaak_f32 v68, v68, v26, 0x358637bd
    v_exp_f32_e64 v37, v37 clamp
    v_fmaak_f32 v69, v69, v26, 0x358637bd
    v_exp_f32_e64 v38, v38 clamp
    v_fmaak_f32 v70, v70, v26, 0x358637bd
    v_exp_f32_e64 v39, v39 clamp
    v_fmaak_f32 v71, v71, v26, 0x358637bd
    v_max_f32 v64, 0x358637bd, v64
    v_max_f32 v65, 0x358637bd, v65
    v_max_f32 v66, 0x358637bd, v66
    v_max_f32 v67, 0x358637bd, v67
    v_max_f32 v68, 0x358637bd, v68
    v_max_f32 v69, 0x358637bd, v69
    v_max_f32 v70, 0x358637bd, v70
    v_max_f32 v71, 0x358637bd, v71
    v_add_f32 v64, v64, v32
    v_add_f32 v65, v65, v33
    v_add_f32 v66, v66, v34
    v_add_f32 v67, v67, v35
    v_add_f32 v68, v68, v36
    v_add_f32 v69, v69, v37
    v_add_f32 v70, v70, v38
    v_add_f32 v71, v71, v39
    v_cvt_pk_bf16_f32 v40, v64, v65
    v_cvt_pk_bf16_f32 v41, v66, v67
    v_cvt_pk_bf16_f32 v42, v68, v69
    v_cvt_pk_bf16_f32 v43, v70, v71
    v_mul_f32 v32, v72, v27
    v_mul_f32 v33, v73, v27
    v_mul_f32 v34, v74, v27
    v_mul_f32 v35, v75, v27
    v_mul_f32 v36, v76, v27
    v_mul_f32 v37, v77, v27
    v_mul_f32 v38, v78, v27
    v_mul_f32 v39, v79, v27
    v_exp_f32_e64 v32, v32 clamp
    v_fmaak_f32 v72, v72, v26, 0x358637bd
    v_exp_f32_e64 v33, v33 clamp
    v_fmaak_f32 v73, v73, v26, 0x358637bd
    v_exp_f32_e64 v34, v34 clamp
    v_fmaak_f32 v74, v74, v26, 0x358637bd
    v_exp_f32_e64 v35, v35 clamp
    v_fmaak_f32 v75, v75, v26, 0x358637bd
    v_exp_f32_e64 v36, v36 clamp
    v_fmaak_f32 v76, v76, v26, 0x358637bd
    v_exp_f32_e64 v37, v37 clamp
    v_fmaak_f32 v77, v77, v26, 0x358637bd
    v_exp_f32_e64 v38, v38 clamp
    v_fmaak_f32 v78, v78, v26, 0x358637bd
    v_exp_f32_e64 v39, v39 clamp
    v_fmaak_f32 v79, v79, v26, 0x358637bd
    v_max_f32 v72, 0x358637bd, v72
    v_max_f32 v73, 0x358637bd, v73
    v_max_f32 v74, 0x358637bd, v74
    v_max_f32 v75, 0x358637bd, v75
    v_max_f32 v76, 0x358637bd, v76
    v_max_f32 v77, 0x358637bd, v77
    v_max_f32 v78, 0x358637bd, v78
    v_max_f32 v79, 0x358637bd, v79
    v_add_f32 v72, v72, v32
    v_add_f32 v73, v73, v33
    v_add_f32 v74, v74, v34
    v_add_f32 v75, v75, v35
    v_add_f32 v76, v76, v36
    v_add_f32 v77, v77, v37
    v_add_f32 v78, v78, v38
    v_add_f32 v79, v79, v39
    v_cvt_pk_bf16_f32 v44, v72, v73
    v_cvt_pk_bf16_f32 v45, v74, v75
    v_cvt_pk_bf16_f32 v46, v76, v77
    v_cvt_pk_bf16_f32 v47, v78, v79
    v_and_b32 v46, v28, v46
    v_and_b32 v47, v28, v47
    buffer_store_dwordx4 v[40:43], v1, s[36:39], s66 offen offset:2048 sc1
    buffer_store_dwordx4 v[44:47], v1, s[36:39], s66 offen offset:3072 sc1
    s_nop 1
    v_mul_f32 v32, v80, v27
    v_mul_f32 v33, v81, v27
    v_mul_f32 v34, v82, v27
    v_mul_f32 v35, v83, v27
    v_mul_f32 v36, v84, v27
    v_mul_f32 v37, v85, v27
    v_mul_f32 v38, v86, v27
    v_mul_f32 v39, v87, v27
    v_exp_f32_e64 v32, v32 clamp
    v_fmaak_f32 v80, v80, v26, 0x358637bd
    v_exp_f32_e64 v33, v33 clamp
    v_fmaak_f32 v81, v81, v26, 0x358637bd
    v_exp_f32_e64 v34, v34 clamp
    v_fmaak_f32 v82, v82, v26, 0x358637bd
    v_exp_f32_e64 v35, v35 clamp
    v_fmaak_f32 v83, v83, v26, 0x358637bd
    v_exp_f32_e64 v36, v36 clamp
    v_fmaak_f32 v84, v84, v26, 0x358637bd
    v_exp_f32_e64 v37, v37 clamp
    v_fmaak_f32 v85, v85, v26, 0x358637bd
    v_exp_f32_e64 v38, v38 clamp
    v_fmaak_f32 v86, v86, v26, 0x358637bd
    v_exp_f32_e64 v39, v39 clamp
    v_fmaak_f32 v87, v87, v26, 0x358637bd
    v_max_f32 v80, 0x358637bd, v80
    v_max_f32 v81, 0x358637bd, v81
    v_max_f32 v82, 0x358637bd, v82
    v_max_f32 v83, 0x358637bd, v83
    v_max_f32 v84, 0x358637bd, v84
    v_max_f32 v85, 0x358637bd, v85
    v_max_f32 v86, 0x358637bd, v86
    v_max_f32 v87, 0x358637bd, v87
    v_add_f32 v80, v80, v32
    v_add_f32 v81, v81, v33
    v_add_f32 v82, v82, v34
    v_add_f32 v83, v83, v35
    v_add_f32 v84, v84, v36
    v_add_f32 v85, v85, v37
    v_add_f32 v86, v86, v38
    v_add_f32 v87, v87, v39
    v_cvt_pk_bf16_f32 v40, v80, v81
    v_cvt_pk_bf16_f32 v41, v82, v83
    v_cvt_pk_bf16_f32 v42, v84, v85
    v_cvt_pk_bf16_f32 v43, v86, v87
    v_mul_f32 v32, v88, v27
    v_mul_f32 v33, v89, v27
    v_mul_f32 v34, v90, v27
    v_mul_f32 v35, v91, v27
    v_mul_f32 v36, v92, v27
    v_mul_f32 v37, v93, v27
    v_mul_f32 v38, v94, v27
    v_mul_f32 v39, v95, v27
    v_exp_f32_e64 v32, v32 clamp
    v_fmaak_f32 v88, v88, v26, 0x358637bd
    v_exp_f32_e64 v33, v33 clamp
    v_fmaak_f32 v89, v89, v26, 0x358637bd
    v_exp_f32_e64 v34, v34 clamp
    v_fmaak_f32 v90, v90, v26, 0x358637bd
    v_exp_f32_e64 v35, v35 clamp
    v_fmaak_f32 v91, v91, v26, 0x358637bd
    v_exp_f32_e64 v36, v36 clamp
    v_fmaak_f32 v92, v92, v26, 0x358637bd
    v_exp_f32_e64 v37, v37 clamp
    v_fmaak_f32 v93, v93, v26, 0x358637bd
    v_exp_f32_e64 v38, v38 clamp
    v_fmaak_f32 v94, v94, v26, 0x358637bd
    v_exp_f32_e64 v39, v39 clamp
    v_fmaak_f32 v95, v95, v26, 0x358637bd
    v_max_f32 v88, 0x358637bd, v88
    v_max_f32 v89, 0x358637bd, v89
    v_max_f32 v90, 0x358637bd, v90
    v_max_f32 v91, 0x358637bd, v91
    v_max_f32 v92, 0x358637bd, v92
    v_max_f32 v93, 0x358637bd, v93
    v_max_f32 v94, 0x358637bd, v94
    v_max_f32 v95, 0x358637bd, v95
    v_add_f32 v88, v88, v32
    v_add_f32 v89, v89, v33
    v_add_f32 v90, v90, v34
    v_add_f32 v91, v91, v35
    v_add_f32 v92, v92, v36
    v_add_f32 v93, v93, v37
    v_add_f32 v94, v94, v38
    v_add_f32 v95, v95, v39
    v_cvt_pk_bf16_f32 v44, v88, v89
    v_cvt_pk_bf16_f32 v45, v90, v91
    v_cvt_pk_bf16_f32 v46, v92, v93
    v_cvt_pk_bf16_f32 v47, v94, v95
    v_and_b32 v46, v28, v46
    v_and_b32 v47, v28, v47
    s_add_u32 s66, s66, 4096
    buffer_store_dwordx4 v[40:43], v1, s[36:39], s66 offen offset:0 sc1
    buffer_store_dwordx4 v[44:47], v1, s[36:39], s66 offen offset:1024 sc1
    s_nop 1
    v_mul_f32 v32, v96, v27
    v_mul_f32 v33, v97, v27
    v_mul_f32 v34, v98, v27
    v_mul_f32 v35, v99, v27
    v_mul_f32 v36, v100, v27
    v_mul_f32 v37, v101, v27
    v_mul_f32 v38, v102, v27
    v_mul_f32 v39, v103, v27
    v_exp_f32_e64 v32, v32 clamp
    v_fmaak_f32 v96, v96, v26, 0x358637bd
    v_exp_f32_e64 v33, v33 clamp
    v_fmaak_f32 v97, v97, v26, 0x358637bd
    v_exp_f32_e64 v34, v34 clamp
    v_fmaak_f32 v98, v98, v26, 0x358637bd
    v_exp_f32_e64 v35, v35 clamp
    v_fmaak_f32 v99, v99, v26, 0x358637bd
    v_exp_f32_e64 v36, v36 clamp
    v_fmaak_f32 v100, v100, v26, 0x358637bd
    v_exp_f32_e64 v37, v37 clamp
    v_fmaak_f32 v101, v101, v26, 0x358637bd
    v_exp_f32_e64 v38, v38 clamp
    v_fmaak_f32 v102, v102, v26, 0x358637bd
    v_exp_f32_e64 v39, v39 clamp
    v_fmaak_f32 v103, v103, v26, 0x358637bd
    v_max_f32 v96, 0x358637bd, v96
    v_max_f32 v97, 0x358637bd, v97
    v_max_f32 v98, 0x358637bd, v98
    v_max_f32 v99, 0x358637bd, v99
    v_max_f32 v100, 0x358637bd, v100
    v_max_f32 v101, 0x358637bd, v101
    v_max_f32 v102, 0x358637bd, v102
    v_max_f32 v103, 0x358637bd, v103
    v_add_f32 v96, v96, v32
    v_add_f32 v97, v97, v33
    v_add_f32 v98, v98, v34
    v_add_f32 v99, v99, v35
    v_add_f32 v100, v100, v36
    v_add_f32 v101, v101, v37
    v_add_f32 v102, v102, v38
    v_add_f32 v103, v103, v39
    v_cvt_pk_bf16_f32 v40, v96, v97
    v_cvt_pk_bf16_f32 v41, v98, v99
    v_cvt_pk_bf16_f32 v42, v100, v101
    v_cvt_pk_bf16_f32 v43, v102, v103
    v_mul_f32 v32, v104, v27
    v_mul_f32 v33, v105, v27
    v_mul_f32 v34, v106, v27
    v_mul_f32 v35, v107, v27
    v_mul_f32 v36, v108, v27
    v_mul_f32 v37, v109, v27
    v_mul_f32 v38, v110, v27
    v_mul_f32 v39, v111, v27
    v_exp_f32_e64 v32, v32 clamp
    v_fmaak_f32 v104, v104, v26, 0x358637bd
    v_exp_f32_e64 v33, v33 clamp
    v_fmaak_f32 v105, v105, v26, 0x358637bd
    v_exp_f32_e64 v34, v34 clamp
    v_fmaak_f32 v106, v106, v26, 0x358637bd
    v_exp_f32_e64 v35, v35 clamp
    v_fmaak_f32 v107, v107, v26, 0x358637bd
    v_exp_f32_e64 v36, v36 clamp
    v_fmaak_f32 v108, v108, v26, 0x358637bd
    v_exp_f32_e64 v37, v37 clamp
    v_fmaak_f32 v109, v109, v26, 0x358637bd
    v_exp_f32_e64 v38, v38 clamp
    v_fmaak_f32 v110, v110, v26, 0x358637bd
    v_exp_f32_e64 v39, v39 clamp
    v_fmaak_f32 v111, v111, v26, 0x358637bd
    v_max_f32 v104, 0x358637bd, v104
    v_max_f32 v105, 0x358637bd, v105
    v_max_f32 v106, 0x358637bd, v106
    v_max_f32 v107, 0x358637bd, v107
    v_max_f32 v108, 0x358637bd, v108
    v_max_f32 v109, 0x358637bd, v109
    v_max_f32 v110, 0x358637bd, v110
    v_max_f32 v111, 0x358637bd, v111
    v_add_f32 v104, v104, v32
    v_add_f32 v105, v105, v33
    v_add_f32 v106, v106, v34
    v_add_f32 v107, v107, v35
    v_add_f32 v108, v108, v36
    v_add_f32 v109, v109, v37
    v_add_f32 v110, v110, v38
    v_add_f32 v111, v111, v39
    v_cvt_pk_bf16_f32 v44, v104, v105
    v_cvt_pk_bf16_f32 v45, v106, v107
    v_cvt_pk_bf16_f32 v46, v108, v109
    v_cvt_pk_bf16_f32 v47, v110, v111
    v_and_b32 v46, v28, v46
    v_and_b32 v47, v28, v47
    buffer_store_dwordx4 v[40:43], v1, s[36:39], s66 offen offset:2048 sc1
    buffer_store_dwordx4 v[44:47], v1, s[36:39], s66 offen offset:3072 sc1
    s_nop 1
    s_lshl_b32 s64, s57, 1
    s_add_u32 s64, s64, s54
    s_lshl_b32 s64, s64, 5
    s_add_u32 s64, s64, s55
    s_lshl_b32 s64, s64, 2
    s_add_u32 s64, s64, 0xa14020
    s_waitcnt vmcnt(0)
    buffer_store_dword v30, off, s[36:39], s64 offset:0 sc1
    s_endpgm
L_H:
    s_add_u32 s71, s71, 3
    s_cmp_ge_u32 s71, 7
    s_cselect_b32 s64, 7, 0
    s_sub_u32 s71, s71, s64
    s_add_u32 m0, s66, 12288
    s_lshl_b32 s68, s71, 7
    s_add_u32 s68, s68, s58
    s_add_u32 s71, s71, 1
    s_cmp_eq_u32 s71, 7
    s_cselect_b32 s71, 0, s71
    buffer_load_dwordx4 v2, s[24:27], s68 offen offset:0 lds
    buffer_load_dwordx4 v3, s[24:27], s68 offen offset:1024 lds
    buffer_load_dwordx4 v4, s[24:27], s68 offen offset:2048 lds
    buffer_load_dwordx4 v5, s[24:27], s68 offen offset:3072 lds
    s_add_u32 m0, s66, 16384
    s_lshl_b32 s68, s71, 7
    s_add_u32 s68, s68, s58
    s_add_u32 s71, s71, 1
    s_cmp_eq_u32 s71, 7
    s_cselect_b32 s71, 0, s71
    buffer_load_dwordx4 v2, s[24:27], s68 offen offset:0 lds
    buffer_load_dwordx4 v3, s[24:27], s68 offen offset:1024 lds
    buffer_load_dwordx4 v4, s[24:27], s68 offen offset:2048 lds
    buffer_load_dwordx4 v5, s[24:27], s68 offen offset:3072 lds
    s_add_u32 m0, s66, 20480
    s_lshl_b32 s68, s71, 7
    s_add_u32 s68, s68, s58
    s_add_u32 s71, s71, 1
    s_cmp_eq_u32 s71, 7
    s_cselect_b32 s71, 0, s71
    buffer_load_dwordx4 v2, s[24:27], s68 offen offset:0 lds
    buffer_load_dwordx4 v3, s[24:27], s68 offen offset:1024 lds
    buffer_load_dwordx4 v4, s[24:27], s68 offen offset:2048 lds
    buffer_load_dwordx4 v5, s[24:27], s68 offen offset:3072 lds
    s_add_u32 m0, s66, 24576
    s_lshl_b32 s68, s71, 7
    s_add_u32 s68, s68, s58
    s_add_u32 s71, s71, 1
    s_cmp_eq_u32 s71, 7
    s_cselect_b32 s71, 0, s71
    buffer_load_dwordx4 v2, s[24:27], s68 offen offset:0 lds
    buffer_load_dwordx4 v3, s[24:27], s68 offen offset:1024 lds
    buffer_load_dwordx4 v4, s[24:27], s68 offen offset:2048 lds
    buffer_load_dwordx4 v5, s[24:27], s68 offen offset:3072 lds
    s_mov_b32 s28, s6
    s_mov_b32 s29, s7
    s_mov_b32 s30, 0x126000
    s_mov_b32 s31, 0x20000
    v_lshrrev_b32 v20, 3, v0
    v_mul_u32_u24 v10, 2688, v20
    v_lshrrev_b32 v21, 1, v20
    v_lshrrev_b32 v22, 2, v0
    v_xor_b32 v21, v21, v22
    v_and_b32 v21, 1, v21
    v_mul_u32_u24 v21, 896, v21
    v_and_b32 v22, 3, v0
    v_lshlrev_b32 v22, 4, v22
    v_add3_u32 v10, v10, v21, v22
    v_add_u32 v10, 896, v10
    s_mul_i32 s59, s56, 56
    s_mul_i32 s64, s52, 21504
    s_add_u32 s59, s59, s64
    s_add_u32 s11, s59, 0x126000
    s_mul_i32 s64, s70, 172032
    s_add_u32 s59, s59, s64
    s_sub_u32 s59, s59, 0x15000
    s_mov_b32 s36, s22
    s_mov_b32 s37, s23
    s_mov_b32 s38, 0xc00000
    s_mov_b32 s39, 0x20000
    s_mov_b32 s40, s16
    s_mov_b32 s41, s17
    s_mov_b32 s42, 0x188000
    s_mov_b32 s43, 0x20000
    s_mov_b32 s44, s8
    s_mov_b32 s45, s9
    s_mov_b32 s46, 0x62000
    s_mov_b32 s47, 0x20000
    v_lshlrev_b32 v1, 4, v0
    s_cmp_eq_u32 s55, 7
    s_cbranch_scc1 L_parq
    s_and_b32 s64, s52, 1
    s_cmp_eq_u32 s64, 0
    s_cselect_b32 s32, s12, s14
    s_cselect_b32 s33, s13, s15
    s_mov_b32 s34, 0x188000
    s_mov_b32 s35, 0x20000
    v_lshrrev_b32 v20, 3, v0
    v_mul_u32_u24 v11, 3584, v20
    v_lshrrev_b32 v21, 1, v20
    v_and_b32 v21, 1, v21
    s_lshl_b32 s64, s64, 1
    v_or_b32 v21, s64, v21
    v_and_b32 v22, 7, v0
    v_lshrrev_b32 v22, 1, v22
    v_xor_b32 v21, v21, v22
    v_lshlrev_b32 v21, 5, v21
    v_and_b32 v22, 1, v0
    v_lshlrev_b32 v22, 4, v22
    v_add3_u32 v11, v11, v21, v22
    s_mul_i32 s60, s54, 7
    s_add_u32 s60, s60, s55
    s_lshl_b32 s60, s60, 8
    s_lshr_b32 s64, s52, 1
    s_mul_i32 s64, s64, 28672
    s_add_u32 s60, s60, s64
    s_add_u32 s62, s60, 128
    s_mov_b32 s61, 57344
    s_sub_u32 s60, s60, s61
    s_branch L_pardone
L_parq:
    s_mov_b32 s32, s6
    s_mov_b32 s33, s7
    s_mov_b32 s34, 0x126000
    s_mov_b32 s35, 0x20000
    v_lshrrev_b32 v20, 4, v0
    v_mul_u32_u24 v11, 2688, v20
    v_lshlrev_b32 v21, 2, v20
    v_sub_u32 v21, v0, v21
    v_and_b32 v21, 15, v21
    v_lshl_add_u32 v11, v21, 4, v11
    s_mul_i32 s60, s54, 448
    s_mul_i32 s64, s52, 10752
    s_add_u32 s60, s60, s64
    s_add_u32 s62, s60, 224
    s_mov_b32 s61, 43008
    s_sub_u32 s60, s60, s61
L_pardone:
    s_mul_i32 s10, s61, 28
    s_add_u32 s15, s60, s61
    s_add_u32 s15, s15, s10
    s_mul_i32 s64, s70, s61
    s_lshl_b32 s64, s64, 2
    s_add_u32 s60, s60, s64
    s_add_u32 s62, s62, s64
    v_and_b32 v20, 31, v0
    v_lshrrev_b32 v21, 5, v0
    v_and_b32 v22, 7, v20
    v_lshrrev_b32 v23, 4, v20
    v_xor_b32 v23, v23, v22
    v_xor_b32 v23, v23, v21
    v_lshlrev_b32 v23, 4, v23
    v_lshl_add_u32 v23, v22, 7, v23
    v_lshrrev_b32 v22, 3, v20
    v_lshl_add_u32 v23, v22, 10, v23
    v_add_u32 v6, s66, v23
    v_xor_b32 v7, 32, v6
    v_xor_b32 v8, 64, v6
    v_xor_b32 v9, 96, v6
    v_mov_b32 v24, 0
    v_mov_b32 v25, 0
    v_mov_b32 v26, 0
    v_mov_b32 v27, 0
    v_mov_b32 v28, 0x3f803f80
    s_waitcnt vmcnt(12)
    ds_read_b128 v[48:51], v6 offset:12288
    ds_read_b128 v[52:55], v7 offset:12288
    ds_read_b128 v[56:59], v8 offset:12288
    ds_read_b128 v[60:63], v9 offset:12288
    s_waitcnt vmcnt(8) lgkmcnt(0)
    ds_read_b128 v[64:67], v6 offset:16384
    ds_read_b128 v[68:71], v7 offset:16384
    ds_read_b128 v[72:75], v8 offset:16384
    ds_read_b128 v[76:79], v9 offset:16384
    s_add_u32 m0, s63, 0x0
    s_add_u32 s59, s59, 0x15000
    buffer_load_dwordx4 v10, s[28:31], s59 offen lds
    v_dot2c_f32_bf16 v24, v48, v28
    v_dot2c_f32_bf16 v26, v48, v48
    v_dot2c_f32_bf16 v25, v49, v28
    v_dot2c_f32_bf16 v27, v49, v49
    v_dot2c_f32_bf16 v24, v50, v28
    v_dot2c_f32_bf16 v26, v50, v50
    v_dot2c_f32_bf16 v25, v51, v28
    v_dot2c_f32_bf16 v27, v51, v51
    v_dot2c_f32_bf16 v24, v52, v28
    v_dot2c_f32_bf16 v26, v52, v52
    v_dot2c_f32_bf16 v25, v53, v28
    v_dot2c_f32_bf16 v27, v53, v53
    v_dot2c_f32_bf16 v24, v54, v28
    v_dot2c_f32_bf16 v26, v54, v54
    v_dot2c_f32_bf16 v25, v55, v28
    v_dot2c_f32_bf16 v27, v55, v55
    v_dot2c_f32_bf16 v24, v56, v28
    v_dot2c_f32_bf16 v26, v56, v56
    v_dot2c_f32_bf16 v25, v57, v28
    v_dot2c_f32_bf16 v27, v57, v57
    v_dot2c_f32_bf16 v24, v58, v28
    v_dot2c_f32_bf16 v26, v58, v58
    v_dot2c_f32_bf16 v25, v59, v28
    v_dot2c_f32_bf16 v27, v59, v59
    v_dot2c_f32_bf16 v24, v60, v28
    v_dot2c_f32_bf16 v26, v60, v60
    v_dot2c_f32_bf16 v25, v61, v28
    v_dot2c_f32_bf16 v27, v61, v61
    v_dot2c_f32_bf16 v24, v62, v28
    v_dot2c_f32_bf16 v26, v62, v62
    v_dot2c_f32_bf16 v25, v63, v28
    v_dot2c_f32_bf16 v27, v63, v63
    s_waitcnt vmcnt(5) lgkmcnt(0)
    ds_read_b128 v[80:83], v6 offset:20480
    ds_read_b128 v[84:87], v7 offset:20480
    ds_read_b128 v[88:91], v8 offset:20480
    ds_read_b128 v[92:95], v9 offset:20480
    s_add_u32 m0, s63, 0x1000
    s_add_u32 s59, s59, 0x15000
    buffer_load_dwordx4 v10, s[28:31], s59 offen lds
    v_dot2c_f32_bf16 v24, v64, v28
    v_dot2c_f32_bf16 v26, v64, v64
    v_dot2c_f32_bf16 v25, v65, v28
    v_dot2c_f32_bf16 v27, v65, v65
    v_dot2c_f32_bf16 v24, v66, v28
    v_dot2c_f32_bf16 v26, v66, v66
    v_dot2c_f32_bf16 v25, v67, v28
    v_dot2c_f32_bf16 v27, v67, v67
    v_dot2c_f32_bf16 v24, v68, v28
    v_dot2c_f32_bf16 v26, v68, v68
    v_dot2c_f32_bf16 v25, v69, v28
    v_dot2c_f32_bf16 v27, v69, v69
    v_dot2c_f32_bf16 v24, v70, v28
    v_dot2c_f32_bf16 v26, v70, v70
    v_dot2c_f32_bf16 v25, v71, v28
    v_dot2c_f32_bf16 v27, v71, v71
    v_dot2c_f32_bf16 v24, v72, v28
    v_dot2c_f32_bf16 v26, v72, v72
    v_dot2c_f32_bf16 v25, v73, v28
    v_dot2c_f32_bf16 v27, v73, v73
    v_dot2c_f32_bf16 v24, v74, v28
    v_dot2c_f32_bf16 v26, v74, v74
    v_dot2c_f32_bf16 v25, v75, v28
    v_dot2c_f32_bf16 v27, v75, v75
    v_dot2c_f32_bf16 v24, v76, v28
    v_dot2c_f32_bf16 v26, v76, v76
    v_dot2c_f32_bf16 v25, v77, v28
    v_dot2c_f32_bf16 v27, v77, v77
    v_dot2c_f32_bf16 v24, v78, v28
    v_dot2c_f32_bf16 v26, v78, v78
    v_dot2c_f32_bf16 v25, v79, v28
    v_dot2c_f32_bf16 v27, v79, v79
    s_waitcnt vmcnt(2) lgkmcnt(0)
    ds_read_b128 v[96:99], v6 offset:24576
    ds_read_b128 v[100:103], v7 offset:24576
    ds_read_b128 v[104:107], v8 offset:24576
    ds_read_b128 v[108:111], v9 offset:24576
    s_add_u32 m0, s63, 0x2000
    s_add_u32 s59, s59, 0x15000
    s_cmp_ge_u32 s59, s11
    s_cselect_b32 s65, 0x126000, 0
    s_sub_u32 s59, s59, s65
    buffer_load_dwordx4 v10, s[28:31], s59 offen lds
    v_dot2c_f32_bf16 v24, v80, v28
    v_dot2c_f32_bf16 v26, v80, v80
    v_dot2c_f32_bf16 v25, v81, v28
    v_dot2c_f32_bf16 v27, v81, v81
    v_dot2c_f32_bf16 v24, v82, v28
    v_dot2c_f32_bf16 v26, v82, v82
    v_dot2c_f32_bf16 v25, v83, v28
    v_dot2c_f32_bf16 v27, v83, v83
    v_dot2c_f32_bf16 v24, v84, v28
    v_dot2c_f32_bf16 v26, v84, v84
    v_dot2c_f32_bf16 v25, v85, v28
    v_dot2c_f32_bf16 v27, v85, v85
    v_dot2c_f32_bf16 v24, v86, v28
    v_dot2c_f32_bf16 v26, v86, v86
    v_dot2c_f32_bf16 v25, v87, v28
    v_dot2c_f32_bf16 v27, v87, v87
    v_dot2c_f32_bf16 v24, v88, v28
    v_dot2c_f32_bf16 v26, v88, v88
    v_dot2c_f32_bf16 v25, v89, v28
    v_dot2c_f32_bf16 v27, v89, v89
    v_dot2c_f32_bf16 v24, v90, v28
    v_dot2c_f32_bf16 v26, v90, v90
    v_dot2c_f32_bf16 v25, v91, v28
    v_dot2c_f32_bf16 v27, v91, v91
    v_dot2c_f32_bf16 v24, v92, v28
    v_dot2c_f32_bf16 v26, v92, v92
    v_dot2c_f32_bf16 v25, v93, v28
    v_dot2c_f32_bf16 v27, v93, v93
    v_dot2c_f32_bf16 v24, v94, v28
    v_dot2c_f32_bf16 v26, v94, v94
    v_dot2c_f32_bf16 v25, v95, v28
    v_dot2c_f32_bf16 v27, v95, v95
    s_waitcnt lgkmcnt(0)
    v_dot2c_f32_bf16 v24, v96, v28
    v_dot2c_f32_bf16 v26, v96, v96
    v_dot2c_f32_bf16 v25, v97, v28
    v_dot2c_f32_bf16 v27, v97, v97
    v_dot2c_f32_bf16 v24, v98, v28
    v_dot2c_f32_bf16 v26, v98, v98
    v_dot2c_f32_bf16 v25, v99, v28
    v_dot2c_f32_bf16 v27, v99, v99
    v_dot2c_f32_bf16 v24, v100, v28
    v_dot2c_f32_bf16 v26, v100, v100
    v_dot2c_f32_bf16 v25, v101, v28
    v_dot2c_f32_bf16 v27, v101, v101
    v_dot2c_f32_bf16 v24, v102, v28
    v_dot2c_f32_bf16 v26, v102, v102
    v_dot2c_f32_bf16 v25, v103, v28
    v_dot2c_f32_bf16 v27, v103, v103
    v_dot2c_f32_bf16 v24, v104, v28
    v_dot2c_f32_bf16 v26, v104, v104
    v_dot2c_f32_bf16 v25, v105, v28
    v_dot2c_f32_bf16 v27, v105, v105
    v_dot2c_f32_bf16 v24, v106, v28
    v_dot2c_f32_bf16 v26, v106, v106
    v_dot2c_f32_bf16 v25, v107, v28
    v_dot2c_f32_bf16 v27, v107, v107
    v_dot2c_f32_bf16 v24, v108, v28
    v_dot2c_f32_bf16 v26, v108, v108
    v_dot2c_f32_bf16 v25, v109, v28
    v_dot2c_f32_bf16 v27, v109, v109
    v_dot2c_f32_bf16 v24, v110, v28
    v_dot2c_f32_bf16 v26, v110, v110
    v_dot2c_f32_bf16 v25, v111, v28
    v_dot2c_f32_bf16 v27, v111, v111
    s_nop 1
    v_add_f32 v24, v24, v25
    v_add_f32 v26, v26, v27
    s_lshl_b32 s64, s52, 9
    v_lshlrev_b32 v20, 2, v0
    v_add_u32 v20, s64, v20
    ds_write_b32 v20, v24 offset:45056
    ds_write_b32 v20, v26 offset:45312
    s_waitcnt lgkmcnt(0)
    s_barrier
    s_add_u32 m0, s63, 0x3000
    s_add_u32 s59, s59, 0x15000
    buffer_load_dwordx4 v10, s[28:31], s59 offen lds
    s_add_u32 m0, s63, 0x4000
    s_add_u32 s59, s59, 0x15000
    s_cmp_ge_u32 s59, s11
    s_cselect_b32 s65, 0x126000, 0
    s_sub_u32 s59, s59, s65
    buffer_load_dwordx4 v10, s[28:31], s59 offen lds
    s_add_u32 m0, s63, 0x5000
    s_add_u32 s59, s59, 0x15000
    buffer_load_dwordx4 v10, s[28:31], s59 offen lds
    s_add_u32 m0, s63, 0x6000
    s_add_u32 s59, s59, 0x15000
    s_cmp_ge_u32 s59, s11
    s_cselect_b32 s65, 0x126000, 0
    s_sub_u32 s59, s59, s65
    buffer_load_dwordx4 v10, s[28:31], s59 offen lds
    s_add_u32 m0, s63, 0x7000
    s_add_u32 s59, s59, 0x15000
    buffer_load_dwordx4 v10, s[28:31], s59 offen lds
    s_add_u32 m0, s63, 0x8000
    s_add_u32 s59, s59, 0x15000
    s_cmp_ge_u32 s59, s11
    s_cselect_b32 s65, 0x126000, 0
    s_sub_u32 s59, s59, s65
    buffer_load_dwordx4 v10, s[28:31], s59 offen lds
    s_add_u32 m0, s63, 0x9000
    s_add_u32 s59, s59, 0x15000
    buffer_load_dwordx4 v10, s[28:31], s59 offen lds
    s_add_u32 m0, s63, 0xa000
    s_add_u32 s59, s59, 0x15000
    s_cmp_ge_u32 s59, s11
    s_cselect_b32 s65, 0x126000, 0
    s_sub_u32 s59, s59, s65
    buffer_load_dwordx4 v10, s[28:31], s59 offen lds
    s_waitcnt vmcnt(7)
    s_barrier
    s_add_u32 m0, s63, 0xc000
    s_add_u32 s59, s59, 0x15000
    buffer_load_dwordx4 v10, s[28:31], s59 offen lds
    s_waitcnt vmcnt(4)
    s_barrier
    s_add_u32 m0, s63, 0xd000
    s_add_u32 s59, s59, 0x15000
    s_cmp_ge_u32 s59, s11
    s_cselect_b32 s65, 0x126000, 0
    s_sub_u32 s59, s59, s65
    buffer_load_dwordx4 v10, s[28:31], s59 offen lds
    s_add_u32 m0, s63, 0xe000
    s_add_u32 s59, s59, 0x15000
    buffer_load_dwordx4 v10, s[28:31], s59 offen lds
    s_add_u32 m0, s63, 0x10000
    s_add_u32 s60, s60, s61
    buffer_load_dwordx4 v11, s[32:35], s60 offen lds
    s_add_u32 m0, s63, 0x11000
    s_add_u32 s60, s60, s61
    buffer_load_dwordx4 v11, s[32:35], s60 offen lds
    s_add_u32 m0, s63, 0x12000
    s_add_u32 s60, s60, s61
    buffer_load_dwordx4 v11, s[32:35], s60 offen lds
    s_add_u32 m0, s63, 0x13000
    s_add_u32 s60, s60, s61
    buffer_load_dwordx4 v11, s[32:35], s60 offen lds
    s_lshl_b32 s64, s2, 2
    s_add_u32 s64, s64, s52
    s_lshl_b32 s68, s64, 11
    buffer_load_dwordx4 a[28:31], v1, s[40:43], s68 offen
    buffer_load_dwordx4 a[28:31], v1, s[40:43], s68 offen offset:1024
    s_sub_u32 s64, 1023, s64
    s_lshl_b32 s68, s64, 11
    buffer_load_dwordx4 a[28:31], v1, s[44:47], s68 offen
    buffer_load_dwordx4 a[28:31], v1, s[44:47], s68 offen offset:1024
    s_waitcnt vmcnt(10)
    s_barrier
    s_add_u32 m0, s63, 0x14000
    s_add_u32 s60, s60, s61
    s_cmp_ge_u32 s60, s15
    s_cselect_b32 s65, s10, 0
    s_sub_u32 s60, s60, s65
    buffer_load_dwordx4 v11, s[32:35], s60 offen lds
    s_add_u32 m0, s63, 0x15000
    s_add_u32 s60, s60, s61
    buffer_load_dwordx4 v11, s[32:35], s60 offen lds
    s_add_u32 m0, s63, 0x16000
    s_add_u32 s60, s60, s61
    buffer_load_dwordx4 v11, s[32:35], s60 offen lds
    s_add_u32 m0, s63, 0x17000
    s_add_u32 s60, s60, s61
    buffer_load_dwordx4 v11, s[32:35], s60 offen lds
    s_add_u32 m0, s63, 0x18000
    s_add_u32 s60, s60, s61
    s_cmp_ge_u32 s60, s15
    s_cselect_b32 s65, s10, 0
    s_sub_u32 s60, s60, s65
    buffer_load_dwordx4 v11, s[32:35], s60 offen lds
    s_add_u32 m0, s63, 0x19000
    s_add_u32 s60, s60, s61
    buffer_load_dwordx4 v11, s[32:35], s60 offen lds
    s_add_u32 m0, s63, 0x1a000
    s_add_u32 s60, s60, s61
    buffer_load_dwordx4 v11, s[32:35], s60 offen lds
    s_add_u32 m0, s63, 0x1b000
    s_add_u32 s60, s60, s61
    buffer_load_dwordx4 v11, s[32:35], s60 offen lds
    s_waitcnt vmcnt(16)
    s_barrier
    s_add_u32 m0, s63, 0x1c000
    s_add_u32 s60, s60, s61
    s_cmp_ge_u32 s60, s15
    s_cselect_b32 s65, s10, 0
    s_sub_u32 s60, s60, s65
    buffer_load_dwordx4 v11, s[32:35], s60 offen lds
    s_add_u32 m0, s63, 0x1d000
    s_add_u32 s60, s60, s61
    buffer_load_dwordx4 v11, s[32:35], s60 offen lds
    s_add_u32 m0, s63, 0x1e000
    s_add_u32 s60, s60, s61
    buffer_load_dwordx4 v11, s[32:35], s60 offen lds
    s_add_u32 m0, s63, 0x1f000
    s_add_u32 s60, s60, s61
    buffer_load_dwordx4 v11, s[32:35], s60 offen lds
    v_mov_b32 v31, 0
    global_load_dword v30, v31, s[20:21] sc1
    s_waitcnt vmcnt(17)
    s_barrier
    s_add_u32 m0, s63, 0x20000
    s_add_u32 s60, s60, s61
    s_cmp_ge_u32 s60, s15
    s_cselect_b32 s65, s10, 0
    s_sub_u32 s60, s60, s65
    buffer_load_dwordx4 v11, s[32:35], s60 offen lds
    s_add_u32 m0, s63, 0x21000
    s_add_u32 s60, s60, s61
    buffer_load_dwordx4 v11, s[32:35], s60 offen lds
    s_add_u32 m0, s63, 0x22000
    s_add_u32 s60, s60, s61
    buffer_load_dwordx4 v11, s[32:35], s60 offen lds
    s_add_u32 m0, s63, 0x23000
    s_add_u32 s60, s60, s61
    buffer_load_dwordx4 v11, s[32:35], s60 offen lds
    s_barrier
    s_barrier
    s_add_u32 m0, s63, 0x24000
    s_add_u32 s60, s60, s61
    s_cmp_ge_u32 s60, s15
    s_cselect_b32 s65, s10, 0
    s_sub_u32 s60, s60, s65
    buffer_load_dwordx4 v11, s[32:35], s60 offen lds
    s_add_u32 m0, s63, 0x25000
    s_add_u32 s60, s60, s61
    buffer_load_dwordx4 v11, s[32:35], s60 offen lds
    s_add_u32 m0, s63, 0x26000
    s_add_u32 s60, s60, s61
    buffer_load_dwordx4 v11, s[32:35], s60 offen lds
    s_add_u32 m0, s63, 0x27000
    s_add_u32 s60, s60, s61
    buffer_load_dwordx4 v11, s[32:35], s60 offen lds
    s_add_u32 m0, s63, 0x0
    s_add_u32 s60, s60, s61
    s_cmp_ge_u32 s60, s15
    s_cselect_b32 s65, s10, 0
    s_sub_u32 s60, s60, s65
    buffer_load_dwordx4 v11, s[32:35], s60 offen lds
    s_add_u32 m0, s63, 0x1000
    s_add_u32 s60, s60, s61
    buffer_load_dwordx4 v11, s[32:35], s60 offen lds
    s_add_u32 m0, s63, 0x2000
    s_add_u32 s60, s60, s61
    buffer_load_dwordx4 v11, s[32:35], s60 offen lds
    s_add_u32 m0, s63, 0x3000
    s_add_u32 s60, s60, s61
    buffer_load_dwordx4 v11, s[32:35], s60 offen lds
    s_add_u32 m0, s63, 0x4000
    s_mov_b32 s60, s62
    buffer_load_dwordx4 v11, s[32:35], s60 offen lds
    s_add_u32 m0, s63, 0x5000
    s_add_u32 s60, s60, s61
    buffer_load_dwordx4 v11, s[32:35], s60 offen lds
    s_add_u32 m0, s63, 0x6000
    s_add_u32 s60, s60, s61
    buffer_load_dwordx4 v11, s[32:35], s60 offen lds
    s_add_u32 m0, s63, 0x7000
    s_add_u32 s60, s60, s61
    buffer_load_dwordx4 v11, s[32:35], s60 offen lds
    s_waitcnt vmcnt(16)
    v_cmp_eq_u32 vcc, 0, v30
    s_cbranch_vccnz LS_nonceh
LB_nonceh:
    s_nop 1
    v_readfirstlane_b32 s67, v30
    s_nop 1
    s_barrier
    s_add_u32 m0, s63, 0x8000
    s_add_u32 s60, s60, s61
    s_cmp_ge_u32 s60, s15
    s_cselect_b32 s65, s10, 0
    s_sub_u32 s60, s60, s65
    buffer_load_dwordx4 v11, s[32:35], s60 offen lds
    s_add_u32 m0, s63, 0x9000
    s_add_u32 s60, s60, s61
    buffer_load_dwordx4 v11, s[32:35], s60 offen lds
    s_add_u32 m0, s63, 0xa000
    s_add_u32 s60, s60, s61
    buffer_load_dwordx4 v11, s[32:35], s60 offen lds
    s_add_u32 m0, s63, 0xb000
    s_add_u32 s60, s60, s61
    buffer_load_dwordx4 v11, s[32:35], s60 offen lds
    s_barrier
    s_add_u32 m0, s63, 0x10000
    s_add_u32 s60, s60, s61
    s_cmp_ge_u32 s60, s15
    s_cselect_b32 s65, s10, 0
    s_sub_u32 s60, s60, s65
    buffer_load_dwordx4 v11, s[32:35], s60 offen lds
    s_add_u32 m0, s63, 0x11000
    s_add_u32 s60, s60, s61
    buffer_load_dwordx4 v11, s[32:35], s60 offen lds
    s_add_u32 m0, s63, 0x12000
    s_add_u32 s60, s60, s61
    buffer_load_dwordx4 v11, s[32:35], s60 offen lds
    s_add_u32 m0, s63, 0x13000
    s_add_u32 s60, s60, s61
    buffer_load_dwordx4 v11, s[32:35], s60 offen lds
    s_barrier
    s_add_u32 m0, s63, 0x14000
    s_add_u32 s60, s60, s61
    s_cmp_ge_u32 s60, s15
    s_cselect_b32 s65, s10, 0
    s_sub_u32 s60, s60, s65
    buffer_load_dwordx4 v11, s[32:35], s60 offen lds
    s_add_u32 m0, s63, 0x15000
    s_add_u32 s60, s60, s61
    buffer_load_dwordx4 v11, s[32:35], s60 offen lds
    s_add_u32 m0, s63, 0x16000
    s_add_u32 s60, s60, s61
    buffer_load_dwordx4 v11, s[32:35], s60 offen lds
    s_add_u32 m0, s63, 0x17000
    s_add_u32 s60, s60, s61
    buffer_load_dwordx4 v11, s[32:35], s60 offen lds
    s_waitcnt vmcnt(24)
    s_barrier
    s_add_u32 m0, s63, 0x18000
    s_add_u32 s60, s60, s61
    s_cmp_ge_u32 s60, s15
    s_cselect_b32 s65, s10, 0
    s_sub_u32 s60, s60, s65
    buffer_load_dwordx4 v11, s[32:35], s60 offen lds
    s_add_u32 m0, s63, 0x19000
    s_add_u32 s60, s60, s61
    buffer_load_dwordx4 v11, s[32:35], s60 offen lds
    s_add_u32 m0, s63, 0x1a000
    s_add_u32 s60, s60, s61
    buffer_load_dwordx4 v11, s[32:35], s60 offen lds
    s_add_u32 m0, s63, 0x1b000
    s_add_u32 s60, s60, s61
    buffer_load_dwordx4 v11, s[32:35], s60 offen lds
    s_lshl_b32 s7, s56, 2
    s_lshr_b32 s64, s53, 2
    s_add_u32 s7, s7, s64
    s_lshl_b32 s7, s7, 7
    s_add_u32 s7, s7, 0xa10000
    v_and_b32 v31, 15, v0
    v_lshlrev_b32 v31, 2, v31
    buffer_load_dword v2, v31, s[36:39], s7 offen offset:0 sc1
    s_waitcnt vmcnt(25)
    s_barrier
    s_add_u32 m0, s63, 0x1c000
    s_add_u32 s60, s60, s61
    s_cmp_ge_u32 s60, s15
    s_cselect_b32 s65, s10, 0
    s_sub_u32 s60, s60, s65
    buffer_load_dwordx4 v11, s[32:35], s60 offen lds
    s_add_u32 m0, s63, 0x1d000
    s_add_u32 s60, s60, s61
    buffer_load_dwordx4 v11, s[32:35], s60 offen lds
    s_add_u32 m0, s63, 0x1e000
    s_add_u32 s60, s60, s61
    buffer_load_dwordx4 v11, s[32:35], s60 offen lds
    s_add_u32 m0, s63, 0x1f000
    s_add_u32 s60, s60, s61
    buffer_load_dwordx4 v11, s[32:35], s60 offen lds
    s_waitcnt vmcnt(25)
    s_barrier
    s_add_u32 m0, s63, 0x20000
    s_add_u32 s60, s60, s61
    s_cmp_ge_u32 s60, s15
    s_cselect_b32 s65, s10, 0
    s_sub_u32 s60, s60, s65
    buffer_load_dwordx4 v11, s[32:35], s60 offen lds
    s_add_u32 m0, s63, 0x21000
    s_add_u32 s60, s60, s61
    buffer_load_dwordx4 v11, s[32:35], s60 offen lds
    s_add_u32 m0, s63, 0x22000
    s_add_u32 s60, s60, s61
    buffer_load_dwordx4 v11, s[32:35], s60 offen lds
    s_add_u32 m0, s63, 0x23000
    s_add_u32 s60, s60, s61
    buffer_load_dwordx4 v11, s[32:35], s60 offen lds
    s_waitcnt vmcnt(8)
    v_cmp_ne_u32 vcc, s67, v2
    s_cbranch_vccnz LS_fph
LB_fph:
    s_nop 4
    v_lshrrev_b32 v20, 2, v0
    v_lshlrev_b32 v20, 12, v20
    v_and_b32 v21, 3, v0
    v_lshl_add_u32 v20, v21, 4, v20
    s_lshl_b32 s7, s56, 16
    s_lshl_b32 s64, s53, 8
    s_add_u32 s7, s7, s64
    s_lshl_b32 s64, s52, 6
    s_add_u32 s7, s7, s64
    s_add_u32 s7, s7, 0x900000
    buffer_load_dwordx4 v[16:19], v20, s[36:39], s7 offen sc1
    s_barrier
    s_waitcnt vmcnt(0)
    v_add_f32_dpp v16, v16, v16 row_ror:8 row_mask:0xf bank_mask:0xf
    v_add_f32_dpp v17, v17, v17 row_ror:8 row_mask:0xf bank_mask:0xf
    v_add_f32_dpp v18, v18, v18 row_ror:8 row_mask:0xf bank_mask:0xf
    v_add_f32_dpp v19, v19, v19 row_ror:8 row_mask:0xf bank_mask:0xf
    v_add_f32_dpp v16, v16, v16 row_ror:4 row_mask:0xf bank_mask:0xf
    v_add_f32_dpp v17, v17, v17 row_ror:4 row_mask:0xf bank_mask:0xf
    v_add_f32_dpp v18, v18, v18 row_ror:4 row_mask:0xf bank_mask:0xf
    v_add_f32_dpp v19, v19, v19 row_ror:4 row_mask:0xf bank_mask:0xf
    v_mov_b32 v20, v16
    v_mov_b32 v21, v17
    v_mov_b32 v22, v18
    v_mov_b32 v23, v19
    v_permlane16_swap_b32 v16, v20
    v_permlane16_swap_b32 v17, v21
    v_permlane16_swap_b32 v18, v22
    v_permlane16_swap_b32 v19, v23
    v_add_f32 v16, v16, v20
    v_add_f32 v17, v17, v21
    v_add_f32 v18, v18, v22
    v_add_f32 v19, v19, v23
    v_mov_b32 v20, v16
    v_mov_b32 v21, v17
    v_mov_b32 v22, v18
    v_mov_b32 v23, v19
    v_permlane32_swap_b32 v16, v20
    v_permlane32_swap_b32 v17, v21
    v_permlane32_swap_b32 v18, v22
    v_permlane32_swap_b32 v19, v23
    v_add_f32 v16, v16, v20
    v_add_f32 v17, v17, v21
    v_add_f32 v18, v18, v22
    v_add_f32 v19, v19, v23
    v_cvt_pk_bf16_f32 v16, v16, v17
    v_cvt_pk_bf16_f32 v17, v18, v19
    s_cmp_ge_u32 s53, 14
    s_cselect_b32 s64, 0, -1
    v_and_b32 v16, s64, v16
    v_and_b32 v17, s64, v17
    v_and_b32 v20, 3, v0
    v_lshlrev_b32 v20, 4, v20
    s_lshl_b32 s7, s56, 11
    s_lshr_b32 s64, s53, 3
    s_lshl_b32 s64, s64, 10
    s_add_u32 s7, s7, s64
    s_and_b32 s64, s53, 3
    s_lshl_b32 s64, s64, 8
    s_add_u32 s7, s7, s64
    s_lshl_b32 s64, s52, 6
    s_add_u32 s7, s7, s64
    s_bfe_u32 s64, s53, 0x10002
    s_lshl_b32 s64, s64, 3
    s_add_u32 s7, s7, s64
    s_add_u32 s7, s7, 0xa00000
    buffer_store_dwordx2 v[16:17], v20, s[36:39], s7 offen sc1
    s_cmp_eq_u32 s55, 7
    s_cbranch_scc1 L_Hattn
    s_mul_i32 s64, s69, 37
    s_lshr_b32 s64, s64, 8
    s_mul_i32 s65, s64, 7
    s_sub_u32 s11, s69, s65
    s_lshl_b32 s15, s64, 1
    s_add_u32 s15, s15, s11
    s_cmp_ge_u32 s15, 7
    s_cselect_b32 s65, 7, 0
    s_sub_u32 s15, s15, s65
    s_mov_b32 s71, s15
    s_and_b32 s4, s2, 7
    s_lshl_b32 s4, s4, 2
    s_add_u32 s4, s4, s64
    s_and_b32 s3, s52, 1
    s_lshr_b32 s10, s52, 1
    s_lshl_b32 s4, s4, 1
    s_add_u32 s4, s4, s3
    s_lshl_b32 s69, s4, 1
    s_add_u32 s69, s69, s10
    s_lshl_b32 s69, s69, 7
    s_add_u32 s69, s69, 0xa14000
    v_lshrrev_b32 v20, 3, v0
    v_mul_u32_u24 v12, 896, v20
    v_lshrrev_b32 v21, 1, v20
    v_lshrrev_b32 v22, 2, v0
    v_xor_b32 v21, v21, v22
    v_and_b32 v21, 1, v21
    v_lshlrev_b32 v21, 6, v21
    v_and_b32 v22, 3, v0
    v_lshlrev_b32 v22, 4, v22
    v_add3_u32 v12, v12, v21, v22
    s_lshl_b32 s58, s11, 7
    s_mul_i32 s64, s3, 7168
    s_add_u32 s58, s58, s64
    s_mul_i32 s64, s10, 200704
    s_add_u32 s59, s58, s64
    s_mul_i32 s64, s10, 802816
    s_add_u32 s58, s58, s64
    v_bfe_u32 v20, v0, 2, 2
    v_bfe_u32 v21, v0, 4, 1
    v_lshrrev_b32 v22, 5, v0
    v_lshl_add_u32 v22, v22, 2, v20
    v_and_b32 v23, 3, v0
    v_lshlrev_b32 v23, 3, v23
    v_lshlrev_b32 v22, 7, v22
    v_lshl_add_u32 v22, v21, 5, v22
    v_add_u32 v22, v22, v23
    v_lshrrev_b32 v20, 1, v20
    v_lshl_add_u32 v22, v20, 6, v22
    s_lshl_b32 s64, s10, 11
    v_add_u32 v6, s64, v22
    s_lshl_b32 s64, s10, 6
    v_xor_b32 v6, s64, v6
    v_xor_b32 v7, 64, v6
    v_add_u32 v8, 0x10000, v6
    v_add_u32 v9, 0x10000, v7
    v_add_u32 v10, 0x20000, v6
    v_add_u32 v11, 0x20000, v7
    v_cmp_gt_u32 vcc, 32, v0
    s_nop 1
    v_cndmask_b32 v28, 0, -1, vcc
    s_lshl_b32 s64, s56, 4
    s_add_u32 s64, s64, s53
    s_lshl_b32 s64, s64, 2
    s_add_u32 s64, s64, s52
    s_lshl_b32 s64, s64, 2
    s_add_u32 s64, s64, 0xa12000
    s_waitcnt vmcnt(0)
    buffer_store_dword v30, off, s[36:39], s64 offset:0 sc1
    s_barrier
    s_add_u32 m0, s63, 0x24000
    s_mul_i32 s14, s15, 114688
    s_add_u32 s14, s14, s58
    s_add_u32 s15, s15, 1
    s_cmp_eq_u32 s15, 7
    s_cselect_b32 s15, 0, s15
    s_add_u32 s65, s14, 0x0
    buffer_load_dwordx4 v12, s[40:43], s65 offen lds
    s_add_u32 m0, s63, 0x25000
    s_add_u32 s65, s14, 0x3800
    buffer_load_dwordx4 v12, s[40:43], s65 offen lds
    s_add_u32 m0, s63, 0x26000
    s_add_u32 s65, s14, 0x7000
    buffer_load_dwordx4 v12, s[40:43], s65 offen lds
    s_add_u32 m0, s63, 0x27000
    s_add_u32 s65, s14, 0xa800
    buffer_load_dwordx4 v12, s[40:43], s65 offen lds
    s_add_u32 m0, s63, 0x0
    s_mul_i32 s14, s15, 114688
    s_add_u32 s14, s14, s58
    s_add_u32 s15, s15, 1
    s_cmp_eq_u32 s15, 7
    s_cselect_b32 s15, 0, s15
    s_add_u32 s65, s14, 0x0
    buffer_load_dwordx4 v12, s[40:43], s65 offen lds
    s_add_u32 m0, s63, 0x1000
    s_add_u32 s65, s14, 0x3800
    buffer_load_dwordx4 v12, s[40:43], s65 offen lds
    s_add_u32 m0, s63, 0x2000
    s_add_u32 s65, s14, 0x7000
    buffer_load_dwordx4 v12, s[40:43], s65 offen lds
    s_add_u32 m0, s63, 0x3000
    s_add_u32 s65, s14, 0xa800
    buffer_load_dwordx4 v12, s[40:43], s65 offen lds
    s_barrier
    s_add_u32 m0, s63, 0x4000
    s_add_u32 s65, s59, 0x0
    buffer_load_dwordx4 v12, s[44:47], s65 offen lds
    s_add_u32 m0, s63, 0x5000
    s_add_u32 s65, s59, 0x3800
    buffer_load_dwordx4 v12, s[44:47], s65 offen lds
    s_add_u32 m0, s63, 0x6000
    s_add_u32 s65, s59, 0x6200
    buffer_load_dwordx4 v12, s[44:47], s65 offen lds
    s_add_u32 m0, s63, 0x7000
    s_add_u32 s65, s59, 0x9a00
    buffer_load_dwordx4 v12, s[44:47], s65 offen lds
    s_barrier
    s_add_u32 m0, s63, 0x8000
    s_mul_i32 s14, s15, 114688
    s_add_u32 s14, s14, s58
    s_add_u32 s15, s15, 1
    s_cmp_eq_u32 s15, 7
    s_cselect_b32 s15, 0, s15
    s_add_u32 s65, s14, 0x0
    buffer_load_dwordx4 v12, s[40:43], s65 offen lds
    s_add_u32 m0, s63, 0x9000
    s_add_u32 s65, s14, 0x3800
    buffer_load_dwordx4 v12, s[40:43], s65 offen lds
    s_add_u32 m0, s63, 0xa000
    s_add_u32 s65, s14, 0x7000
    buffer_load_dwordx4 v12, s[40:43], s65 offen lds
    s_add_u32 m0, s63, 0xb000
    s_add_u32 s65, s14, 0xa800
    buffer_load_dwordx4 v12, s[40:43], s65 offen lds
    s_barrier
    s_add_u32 m0, s63, 0x10000
    s_mul_i32 s14, s15, 114688
    s_add_u32 s14, s14, s58
    s_add_u32 s15, s15, 1
    s_cmp_eq_u32 s15, 7
    s_cselect_b32 s15, 0, s15
    s_add_u32 s65, s14, 0x0
    buffer_load_dwordx4 v12, s[40:43], s65 offen lds
    s_add_u32 m0, s63, 0x11000
    s_add_u32 s65, s14, 0x3800
    buffer_load_dwordx4 v12, s[40:43], s65 offen lds
    s_add_u32 m0, s63, 0x12000
    s_add_u32 s65, s14, 0x7000
    buffer_load_dwordx4 v12, s[40:43], s65 offen lds
    s_add_u32 m0, s63, 0x13000
    s_add_u32 s65, s14, 0xa800
    buffer_load_dwordx4 v12, s[40:43], s65 offen lds
    s_barrier
    s_add_u32 m0, s63, 0x14000
    s_add_u32 s65, s59, 0xc400
    buffer_load_dwordx4 v12, s[44:47], s65 offen lds
    s_add_u32 m0, s63, 0x15000
    s_add_u32 s65, s59, 0xfc00
    buffer_load_dwordx4 v12, s[44:47], s65 offen lds
    s_add_u32 m0, s63, 0x16000
    s_add_u32 s65, s59, 0x12600
    buffer_load_dwordx4 v12, s[44:47], s65 offen lds
    s_add_u32 m0, s63, 0x17000
    s_add_u32 s65, s59, 0x15e00
    buffer_load_dwordx4 v12, s[44:47], s65 offen lds
    s_barrier
    s_add_u32 m0, s63, 0x18000
    s_mul_i32 s14, s15, 114688
    s_add_u32 s14, s14, s58
    s_add_u32 s15, s15, 1
    s_cmp_eq_u32 s15, 7
    s_cselect_b32 s15, 0, s15
    s_add_u32 s65, s14, 0x0
    buffer_load_dwordx4 v12, s[40:43], s65 offen lds
    s_add_u32 m0, s63, 0x19000
    s_add_u32 s65, s14, 0x3800
    buffer_load_dwordx4 v12, s[40:43], s65 offen lds
    s_add_u32 m0, s63, 0x1a000
    s_add_u32 s65, s14, 0x7000
    buffer_load_dwordx4 v12, s[40:43], s65 offen lds
    s_add_u32 m0, s63, 0x1b000
    s_add_u32 s65, s14, 0xa800
    buffer_load_dwordx4 v12, s[40:43], s65 offen lds
    s_lshl_b32 s7, s10, 11
    s_add_u32 s7, s7, 0xa12000
    v_mov_b32 v31, v1
    buffer_load_dwordx4 v[2:5], v31, s[36:39], s7 offen offset:0 sc1
    buffer_load_dwordx4 v[16:19], v31, s[36:39], s7 offen offset:1024 sc1
    v_mov_b32 v15, 28
    buffer_load_dword v14, v15, s[36:39], s69 offen offset:0 sc1
    s_waitcnt vmcnt(2)
    v_cmp_ne_u32 vcc, s67, v2
    v_cmp_ne_u32 s[12:13], s67, v3
    s_nop 0
    s_or_b64 vcc, vcc, s[12:13]
    v_cmp_ne_u32 s[12:13], s67, v4
    s_nop 0
    s_or_b64 vcc, vcc, s[12:13]
    v_cmp_ne_u32 s[12:13], s67, v5
    s_nop 0
    s_or_b64 vcc, vcc, s[12:13]
    s_cbranch_vccnz LS_fr0
LB_fr0:
    s_nop 4
    s_waitcnt vmcnt(1)
    v_cmp_ne_u32 vcc, s67, v16
    v_cmp_ne_u32 s[12:13], s67, v17
    s_nop 0
    s_or_b64 vcc, vcc, s[12:13]
    v_cmp_ne_u32 s[12:13], s67, v18
    s_nop 0
    s_or_b64 vcc, vcc, s[12:13]
    v_cmp_ne_u32 s[12:13], s67, v19
    s_nop 0
    s_or_b64 vcc, vcc, s[12:13]
    s_cbranch_vccnz LS_fr1
LB_fr1:
    s_nop 4
    s_lshl_b32 s5, s10, 14
    s_add_u32 s5, s5, 0xa00000
    buffer_load_dwordx4 v[160:163], v1, s[36:39], s5 offen offset:0 sc1
    buffer_load_dwordx4 v[164:167], v1, s[36:39], s5 offen offset:1024 sc1
    buffer_load_dwordx4 v[168:171], v1, s[36:39], s5 offen offset:2048 sc1
    buffer_load_dwordx4 v[172:175], v1, s[36:39], s5 offen offset:3072 sc1
    s_add_u32 s5, s5, 4096
    buffer_load_dwordx4 v[176:179], v1, s[36:39], s5 offen offset:0 sc1
    buffer_load_dwordx4 v[180:183], v1, s[36:39], s5 offen offset:1024 sc1
    buffer_load_dwordx4 v[184:187], v1, s[36:39], s5 offen offset:2048 sc1
    buffer_load_dwordx4 v[188:191], v1, s[36:39], s5 offen offset:3072 sc1
    s_add_u32 s5, s5, 4096
    buffer_load_dwordx4 v[192:195], v1, s[36:39], s5 offen offset:0 sc1
    buffer_load_dwordx4 v[196:199], v1, s[36:39], s5 offen offset:1024 sc1
    buffer_load_dwordx4 v[200:203], v1, s[36:39], s5 offen offset:2048 sc1
    buffer_load_dwordx4 v[204:207], v1, s[36:39], s5 offen offset:3072 sc1
    s_add_u32 s5, s5, 4096
    buffer_load_dwordx4 v[208:211], v1, s[36:39], s5 offen offset:0 sc1
    buffer_load_dwordx4 v[212:215], v1, s[36:39], s5 offen offset:1024 sc1
    buffer_load_dwordx4 v[216:219], v1, s[36:39], s5 offen offset:2048 sc1
    buffer_load_dwordx4 v[220:223], v1, s[36:39], s5 offen offset:3072 sc1
    s_waitcnt vmcnt(16)
    v_cmp_ne_u32 vcc, s67, v14
    s_cbranch_vccnz LS_pq0
LB_pq0:
    s_nop 4
    s_lshl_b32 s60, s4, 15
    s_lshl_b32 s64, s10, 14
    s_add_u32 s60, s60, s64
    s_add_u32 s60, s60, 0x700000
    buffer_load_dwordx4 v[128:131], v1, s[36:39], s60 offen offset:0 sc1
    buffer_load_dwordx4 v[132:135], v1, s[36:39], s60 offen offset:1024 sc1
    buffer_load_dwordx4 v[136:139], v1, s[36:39], s60 offen offset:2048 sc1
    buffer_load_dwordx4 v[140:143], v1, s[36:39], s60 offen offset:3072 sc1
    s_add_u32 s60, s60, 4096
    buffer_load_dwordx4 v[144:147], v1, s[36:39], s60 offen offset:0 sc1
    buffer_load_dwordx4 v[148:151], v1, s[36:39], s60 offen offset:1024 sc1
    buffer_load_dwordx4 v[152:155], v1, s[36:39], s60 offen offset:2048 sc1
    buffer_load_dwordx4 v[156:159], v1, s[36:39], s60 offen offset:3072 sc1
    s_barrier
    s_add_u32 m0, s63, 0x1c000
    s_mul_i32 s14, s15, 114688
    s_add_u32 s14, s14, s58
    s_add_u32 s15, s15, 1
    s_cmp_eq_u32 s15, 7
    s_cselect_b32 s15, 0, s15
    s_add_u32 s65, s14, 0x0
    buffer_load_dwordx4 v12, s[40:43], s65 offen lds
    s_add_u32 m0, s63, 0x1d000
    s_add_u32 s65, s14, 0x3800
    buffer_load_dwordx4 v12, s[40:43], s65 offen lds
    s_add_u32 m0, s63, 0x1e000
    s_add_u32 s65, s14, 0x7000
    buffer_load_dwordx4 v12, s[40:43], s65 offen lds
    s_add_u32 m0, s63, 0x1f000
    s_add_u32 s65, s14, 0xa800
    buffer_load_dwordx4 v12, s[40:43], s65 offen lds
    s_add_u32 m0, s63, 0x20000
    s_mul_i32 s14, s15, 114688
    s_add_u32 s14, s14, s58
    s_add_u32 s15, s15, 1
    s_cmp_eq_u32 s15, 7
    s_cselect_b32 s15, 0, s15
    s_add_u32 s65, s14, 0x0
    buffer_load_dwordx4 v12, s[40:43], s65 offen lds
    s_add_u32 m0, s63, 0x21000
    s_add_u32 s65, s14, 0x3800
    buffer_load_dwordx4 v12, s[40:43], s65 offen lds
    s_add_u32 m0, s63, 0x22000
    s_add_u32 s65, s14, 0x7000
    buffer_load_dwordx4 v12, s[40:43], s65 offen lds
    s_add_u32 m0, s63, 0x23000
    s_add_u32 s65, s14, 0xa800
    buffer_load_dwordx4 v12, s[40:43], s65 offen lds
    s_barrier
    ds_read_b64_tr_b16 a[0:1], v6 offset:16384
    ds_read_b64_tr_b16 a[2:3], v6 offset:17408
    ds_read_b64_tr_b16 a[4:5], v7 offset:16384
    ds_read_b64_tr_b16 a[6:7], v7 offset:17408
    ds_read_b64_tr_b16 a[8:9], v6 offset:20480
    ds_read_b64_tr_b16 a[10:11], v6 offset:21504
    ds_read_b64_tr_b16 a[12:13], v7 offset:20480
    ds_read_b64_tr_b16 a[14:15], v7 offset:21504
    s_waitcnt vmcnt(14)
    v_mfma_f32_32x32x16_bf16 v[80:95], v[160:163], v[128:131], 0
    v_mfma_f32_32x32x16_bf16 v[80:95], v[164:167], v[132:135], v[80:95]
    s_waitcnt vmcnt(12)
    v_mfma_f32_32x32x16_bf16 v[96:111], v[168:171], v[136:139], 0
    v_mfma_f32_32x32x16_bf16 v[96:111], v[172:175], v[140:143], v[96:111]
    s_nop 8
    v_mov_b32 v20, v92
    s_nop 1
    v_permlane32_swap_b32 v92, v20
    v_add_f32 v20, 0x358637bd, v20
    v_rcp_f32 v20, v20
    s_nop 0
    v_pk_mul_f32 v[80:81], v[80:81], v[20:21] op_sel_hi:[1,0]
    v_pk_mul_f32 v[82:83], v[82:83], v[20:21] op_sel_hi:[1,0]
    v_pk_mul_f32 v[84:85], v[84:85], v[20:21] op_sel_hi:[1,0]
    v_pk_mul_f32 v[86:87], v[86:87], v[20:21] op_sel_hi:[1,0]
    v_pk_mul_f32 v[88:89], v[88:89], v[20:21] op_sel_hi:[1,0]
    v_pk_mul_f32 v[90:91], v[90:91], v[20:21] op_sel_hi:[1,0]
    v_pk_mul_f32 v[92:93], v[92:93], v[20:21] op_sel_hi:[1,0]
    v_pk_mul_f32 v[94:95], v[94:95], v[20:21] op_sel_hi:[1,0]
    v_cvt_pk_bf16_f32 v112, v80, v81
    v_cvt_pk_bf16_f32 v113, v82, v83
    v_cvt_pk_bf16_f32 v114, v84, v85
    v_cvt_pk_bf16_f32 v115, v86, v87
    v_cvt_pk_bf16_f32 v116, v88, v89
    v_cvt_pk_bf16_f32 v117, v90, v91
    v_cvt_pk_bf16_f32 v118, v92, v93
    v_cvt_pk_bf16_f32 v119, v94, v95
    v_and_b32 v118, v28, v118
    v_and_b32 v119, v28, v119
    s_waitcnt lgkmcnt(4)
    v_mfma_f32_32x32x16_bf16 v[48:63], a[0:3], v[112:115], 0
    v_mfma_f32_32x32x16_bf16 v[64:79], a[4:7], v[112:115], 0
    s_waitcnt lgkmcnt(0)
    v_mfma_f32_32x32x16_bf16 v[48:63], a[8:11], v[116:119], v[48:63]
    v_mfma_f32_32x32x16_bf16 v[64:79], a[12:15], v[116:119], v[64:79]
    s_barrier
    ds_read_b64_tr_b16 a[0:1], v6 offset:24576
    ds_read_b64_tr_b16 a[2:3], v6 offset:25600
    ds_read_b64_tr_b16 a[4:5], v7 offset:24576
    ds_read_b64_tr_b16 a[6:7], v7 offset:25600
    ds_read_b64_tr_b16 a[8:9], v6 offset:28672
    ds_read_b64_tr_b16 a[10:11], v6 offset:29696
    ds_read_b64_tr_b16 a[12:13], v7 offset:28672
    ds_read_b64_tr_b16 a[14:15], v7 offset:29696
    s_add_u32 m0, s63, 0x24000
    s_add_u32 s65, s59, 0x18800
    buffer_load_dwordx4 v12, s[44:47], s65 offen lds
    s_waitcnt vmcnt(11)
    v_mfma_f32_32x32x16_bf16 v[80:95], v[176:179], v[144:147], 0
    v_mfma_f32_32x32x16_bf16 v[80:95], v[180:183], v[148:151], v[80:95]
    v_mov_b32 v20, v108
    s_nop 1
    v_permlane32_swap_b32 v108, v20
    v_add_f32 v20, 0x358637bd, v20
    v_rcp_f32 v20, v20
    s_nop 0
    v_pk_mul_f32 v[96:97], v[96:97], v[20:21] op_sel_hi:[1,0]
    s_add_u32 m0, s63, 0x25000
    s_add_u32 s65, s59, 0x1c000
    buffer_load_dwordx4 v12, s[44:47], s65 offen lds
    v_pk_mul_f32 v[98:99], v[98:99], v[20:21] op_sel_hi:[1,0]
    v_pk_mul_f32 v[100:101], v[100:101], v[20:21] op_sel_hi:[1,0]
    v_pk_mul_f32 v[102:103], v[102:103], v[20:21] op_sel_hi:[1,0]
    v_pk_mul_f32 v[104:105], v[104:105], v[20:21] op_sel_hi:[1,0]
    v_pk_mul_f32 v[106:107], v[106:107], v[20:21] op_sel_hi:[1,0]
    v_pk_mul_f32 v[108:109], v[108:109], v[20:21] op_sel_hi:[1,0]
    v_pk_mul_f32 v[110:111], v[110:111], v[20:21] op_sel_hi:[1,0]
    v_cvt_pk_bf16_f32 v120, v96, v97
    s_add_u32 m0, s63, 0x26000
    s_add_u32 s65, s59, 0x1ea00
    buffer_load_dwordx4 v12, s[44:47], s65 offen lds
    v_cvt_pk_bf16_f32 v121, v98, v99
    v_cvt_pk_bf16_f32 v122, v100, v101
    v_cvt_pk_bf16_f32 v123, v102, v103
    v_cvt_pk_bf16_f32 v124, v104, v105
    v_cvt_pk_bf16_f32 v125, v106, v107
    v_cvt_pk_bf16_f32 v126, v108, v109
    v_cvt_pk_bf16_f32 v127, v110, v111
    v_and_b32 v126, v28, v126
    s_add_u32 m0, s63, 0x27000
    s_add_u32 s65, s59, 0x22200
    buffer_load_dwordx4 v12, s[44:47], s65 offen lds
    v_and_b32 v127, v28, v127
    s_waitcnt lgkmcnt(4)
    v_mfma_f32_32x32x16_bf16 v[48:63], a[0:3], v[120:123], v[48:63]
    v_mfma_f32_32x32x16_bf16 v[64:79], a[4:7], v[120:123], v[64:79]
    s_waitcnt lgkmcnt(0)
    v_mfma_f32_32x32x16_bf16 v[48:63], a[8:11], v[124:127], v[48:63]
    v_mfma_f32_32x32x16_bf16 v[64:79], a[12:15], v[124:127], v[64:79]
    s_barrier
    ds_read_b64_tr_b16 a[0:1], v8 offset:16384
    ds_read_b64_tr_b16 a[2:3], v8 offset:17408
    ds_read_b64_tr_b16 a[4:5], v9 offset:16384
    ds_read_b64_tr_b16 a[6:7], v9 offset:17408
    ds_read_b64_tr_b16 a[8:9], v8 offset:20480
    ds_read_b64_tr_b16 a[10:11], v8 offset:21504
    ds_read_b64_tr_b16 a[12:13], v9 offset:20480
    ds_read_b64_tr_b16 a[14:15], v9 offset:21504
    s_add_u32 m0, s63, 0x0
    s_add_u32 s65, s59, 0x24c00
    buffer_load_dwordx4 v12, s[44:47], s65 offen lds
    s_waitcnt vmcnt(13)
    v_mfma_f32_32x32x16_bf16 v[96:111], v[184:187], v[152:155], 0
    v_mfma_f32_32x32x16_bf16 v[96:111], v[188:191], v[156:159], v[96:111]
    v_mov_b32 v20, v92
    s_nop 1
    v_permlane32_swap_b32 v92, v20
    v_add_f32 v20, 0x358637bd, v20
    v_rcp_f32 v20, v20
    s_nop 0
    v_pk_mul_f32 v[80:81], v[80:81], v[20:21] op_sel_hi:[1,0]
    s_add_u32 m0, s63, 0x1000
    s_add_u32 s65, s59, 0x28400
    buffer_load_dwordx4 v12, s[44:47], s65 offen lds
    v_pk_mul_f32 v[82:83], v[82:83], v[20:21] op_sel_hi:[1,0]
    v_pk_mul_f32 v[84:85], v[84:85], v[20:21] op_sel_hi:[1,0]
    v_pk_mul_f32 v[86:87], v[86:87], v[20:21] op_sel_hi:[1,0]
    v_pk_mul_f32 v[88:89], v[88:89], v[20:21] op_sel_hi:[1,0]
    v_pk_mul_f32 v[90:91], v[90:91], v[20:21] op_sel_hi:[1,0]
    v_pk_mul_f32 v[92:93], v[92:93], v[20:21] op_sel_hi:[1,0]
    v_pk_mul_f32 v[94:95], v[94:95], v[20:21] op_sel_hi:[1,0]
    v_cvt_pk_bf16_f32 v112, v80, v81
    s_add_u32 m0, s63, 0x2000
    s_add_u32 s65, s59, 0x2ae00
    buffer_load_dwordx4 v12, s[44:47], s65 offen lds
    v_cvt_pk_bf16_f32 v113, v82, v83
    v_cvt_pk_bf16_f32 v114, v84, v85
    v_cvt_pk_bf16_f32 v115, v86, v87
    v_cvt_pk_bf16_f32 v116, v88, v89
    v_cvt_pk_bf16_f32 v117, v90, v91
    v_cvt_pk_bf16_f32 v118, v92, v93
    v_cvt_pk_bf16_f32 v119, v94, v95
    v_and_b32 v118, v28, v118
    s_add_u32 m0, s63, 0x3000
    s_add_u32 s65, s59, 0x2e600
    buffer_load_dwordx4 v12, s[44:47], s65 offen lds
    v_and_b32 v119, v28, v119
    s_waitcnt lgkmcnt(4)
    v_mfma_f32_32x32x16_bf16 v[48:63], a[0:3], v[112:115], v[48:63]
    v_mfma_f32_32x32x16_bf16 v[64:79], a[4:7], v[112:115], v[64:79]
    s_waitcnt lgkmcnt(0)
    v_mfma_f32_32x32x16_bf16 v[48:63], a[8:11], v[116:119], v[48:63]
    v_mfma_f32_32x32x16_bf16 v[64:79], a[12:15], v[116:119], v[64:79]
    s_barrier
    ds_read_b64_tr_b16 a[0:1], v8 offset:24576
    ds_read_b64_tr_b16 a[2:3], v8 offset:25600
    ds_read_b64_tr_b16 a[4:5], v9 offset:24576
    ds_read_b64_tr_b16 a[6:7], v9 offset:25600
    s_add_u32 m0, s63, 0x4000
    s_mul_i32 s14, s15, 114688
    s_add_u32 s14, s14, s58
    s_add_u32 s15, s15, 1
    s_cmp_eq_u32 s15, 7
    s_cselect_b32 s15, 0, s15
    s_add_u32 s65, s14, 0xe000
    buffer_load_dwordx4 v12, s[40:43], s65 offen lds
    ds_read_b64_tr_b16 a[8:9], v8 offset:28672
    ds_read_b64_tr_b16 a[10:11], v8 offset:29696
    ds_read_b64_tr_b16 a[12:13], v9 offset:28672
    ds_read_b64_tr_b16 a[14:15], v9 offset:29696
    s_add_u32 m0, s63, 0x5000
    s_add_u32 s65, s14, 0x11800
    buffer_load_dwordx4 v12, s[40:43], s65 offen lds
    v_mov_b32 v20, v108
    s_nop 1
    v_permlane32_swap_b32 v108, v20
    v_add_f32 v20, 0x358637bd, v20
    v_rcp_f32 v20, v20
    s_add_u32 m0, s63, 0x6000
    s_add_u32 s65, s14, 0x15000
    buffer_load_dwordx4 v12, s[40:43], s65 offen lds
    s_nop 0
    v_pk_mul_f32 v[96:97], v[96:97], v[20:21] op_sel_hi:[1,0]
    v_pk_mul_f32 v[98:99], v[98:99], v[20:21] op_sel_hi:[1,0]
    v_pk_mul_f32 v[100:101], v[100:101], v[20:21] op_sel_hi:[1,0]
    s_add_u32 m0, s63, 0x7000
    s_add_u32 s65, s14, 0x18800
    buffer_load_dwordx4 v12, s[40:43], s65 offen lds
    v_pk_mul_f32 v[102:103], v[102:103], v[20:21] op_sel_hi:[1,0]
    v_pk_mul_f32 v[104:105], v[104:105], v[20:21] op_sel_hi:[1,0]
    v_pk_mul_f32 v[106:107], v[106:107], v[20:21] op_sel_hi:[1,0]
    v_pk_mul_f32 v[108:109], v[108:109], v[20:21] op_sel_hi:[1,0]
    s_add_u32 m0, s63, 0x8000
    s_mul_i32 s14, s15, 114688
    s_add_u32 s14, s14, s58
    s_add_u32 s15, s15, 1
    s_cmp_eq_u32 s15, 7
    s_cselect_b32 s15, 0, s15
    s_add_u32 s65, s14, 0xe000
    buffer_load_dwordx4 v12, s[40:43], s65 offen lds
    v_pk_mul_f32 v[110:111], v[110:111], v[20:21] op_sel_hi:[1,0]
    v_cvt_pk_bf16_f32 v120, v96, v97
    v_cvt_pk_bf16_f32 v121, v98, v99
    v_cvt_pk_bf16_f32 v122, v100, v101
    s_add_u32 m0, s63, 0x9000
    s_add_u32 s65, s14, 0x11800
    buffer_load_dwordx4 v12, s[40:43], s65 offen lds
    v_cvt_pk_bf16_f32 v123, v102, v103
    v_cvt_pk_bf16_f32 v124, v104, v105
    v_cvt_pk_bf16_f32 v125, v106, v107
    v_cvt_pk_bf16_f32 v126, v108, v109
    s_add_u32 m0, s63, 0xa000
    s_add_u32 s65, s14, 0x15000
    buffer_load_dwordx4 v12, s[40:43], s65 offen lds
    v_cvt_pk_bf16_f32 v127, v110, v111
    v_and_b32 v126, v28, v126
    v_and_b32 v127, v28, v127
    s_waitcnt lgkmcnt(4)
    v_mfma_f32_32x32x16_bf16 v[48:63], a[0:3], v[120:123], v[48:63]
    s_add_u32 m0, s63, 0xb000
    s_add_u32 s65, s14, 0x18800
    buffer_load_dwordx4 v12, s[40:43], s65 offen lds
    v_mfma_f32_32x32x16_bf16 v[64:79], a[4:7], v[120:123], v[64:79]
    s_waitcnt lgkmcnt(0)
    v_mfma_f32_32x32x16_bf16 v[48:63], a[8:11], v[124:127], v[48:63]
    v_mfma_f32_32x32x16_bf16 v[64:79], a[12:15], v[124:127], v[64:79]
    v_mov_b32 v15, 28
    buffer_load_dword v14, v15, s[36:39], s69 offen offset:32 sc1
    s_waitcnt vmcnt(21)
    s_barrier
    s_add_u32 m0, s63, 0x10000
    s_mul_i32 s14, s15, 114688
    s_add_u32 s14, s14, s58
    s_add_u32 s15, s15, 1
    s_cmp_eq_u32 s15, 7
    s_cselect_b32 s15, 0, s15
    s_add_u32 s65, s14, 0xe000
    buffer_load_dwordx4 v12, s[40:43], s65 offen lds
    s_add_u32 m0, s63, 0x11000
    s_add_u32 s65, s14, 0x11800
    buffer_load_dwordx4 v12, s[40:43], s65 offen lds
    s_add_u32 m0, s63, 0x12000
    s_add_u32 s65, s14, 0x15000
    buffer_load_dwordx4 v12, s[40:43], s65 offen lds
    s_add_u32 m0, s63, 0x13000
    s_add_u32 s65, s14, 0x18800
    buffer_load_dwordx4 v12, s[40:43], s65 offen lds
    s_waitcnt vmcnt(4)
    v_cmp_ne_u32 vcc, s67, v14
    s_cbranch_vccnz LS_pq1
LB_pq1:
    s_nop 4
    s_lshl_b32 s60, s4, 15
    s_lshl_b32 s64, s10, 14
    s_add_u32 s60, s60, s64
    s_add_u32 s60, s60, 0x702000
    buffer_load_dwordx4 v[128:131], v1, s[36:39], s60 offen offset:0 sc1
    buffer_load_dwordx4 v[132:135], v1, s[36:39], s60 offen offset:1024 sc1
    buffer_load_dwordx4 v[136:139], v1, s[36:39], s60 offen offset:2048 sc1
    buffer_load_dwordx4 v[140:143], v1, s[36:39], s60 offen offset:3072 sc1
    s_add_u32 s60, s60, 4096
    buffer_load_dwordx4 v[144:147], v1, s[36:39], s60 offen offset:0 sc1
    buffer_load_dwordx4 v[148:151], v1, s[36:39], s60 offen offset:1024 sc1
    buffer_load_dwordx4 v[152:155], v1, s[36:39], s60 offen offset:2048 sc1
    buffer_load_dwordx4 v[156:159], v1, s[36:39], s60 offen offset:3072 sc1
    s_barrier
    s_add_u32 m0, s63, 0x14000
    s_mul_i32 s14, s15, 114688
    s_add_u32 s14, s14, s58
    s_add_u32 s15, s15, 1
    s_cmp_eq_u32 s15, 7
    s_cselect_b32 s15, 0, s15
    s_add_u32 s65, s14, 0xe000
    buffer_load_dwordx4 v12, s[40:43], s65 offen lds
    s_add_u32 m0, s63, 0x15000
    s_add_u32 s65, s14, 0x11800
    buffer_load_dwordx4 v12, s[40:43], s65 offen lds
    s_add_u32 m0, s63, 0x16000
    s_add_u32 s65, s14, 0x15000
    buffer_load_dwordx4 v12, s[40:43], s65 offen lds
    s_add_u32 m0, s63, 0x17000
    s_add_u32 s65, s14, 0x18800
    buffer_load_dwordx4 v12, s[40:43], s65 offen lds
    s_add_u32 m0, s63, 0x18000
    s_mul_i32 s14, s15, 114688
    s_add_u32 s14, s14, s58
    s_add_u32 s15, s15, 1
    s_cmp_eq_u32 s15, 7
    s_cselect_b32 s15, 0, s15
    s_add_u32 s65, s14, 0xe000
    buffer_load_dwordx4 v12, s[40:43], s65 offen lds
    s_add_u32 m0, s63, 0x19000
    s_add_u32 s65, s14, 0x11800
    buffer_load_dwordx4 v12, s[40:43], s65 offen lds
    s_add_u32 m0, s63, 0x1a000
    s_add_u32 s65, s14, 0x15000
    buffer_load_dwordx4 v12, s[40:43], s65 offen lds
    s_add_u32 m0, s63, 0x1b000
    s_add_u32 s65, s14, 0x18800
    buffer_load_dwordx4 v12, s[40:43], s65 offen lds
    s_barrier
    ds_read_b64_tr_b16 a[0:1], v10 offset:16384
    ds_read_b64_tr_b16 a[2:3], v10 offset:17408
    ds_read_b64_tr_b16 a[4:5], v11 offset:16384
    ds_read_b64_tr_b16 a[6:7], v11 offset:17408
    ds_read_b64_tr_b16 a[8:9], v10 offset:20480
    ds_read_b64_tr_b16 a[10:11], v10 offset:21504
    ds_read_b64_tr_b16 a[12:13], v11 offset:20480
    ds_read_b64_tr_b16 a[14:15], v11 offset:21504
    s_waitcnt vmcnt(14)
    v_mfma_f32_32x32x16_bf16 v[80:95], v[192:195], v[128:131], 0
    v_mfma_f32_32x32x16_bf16 v[80:95], v[196:199], v[132:135], v[80:95]
    s_waitcnt vmcnt(12)
    v_mfma_f32_32x32x16_bf16 v[96:111], v[200:203], v[136:139], 0
    v_mfma_f32_32x32x16_bf16 v[96:111], v[204:207], v[140:143], v[96:111]
    s_nop 8
    v_mov_b32 v20, v92
    s_nop 1
    v_permlane32_swap_b32 v92, v20
    v_add_f32 v20, 0x358637bd, v20
    v_rcp_f32 v20, v20
    s_nop 0
    v_pk_mul_f32 v[80:81], v[80:81], v[20:21] op_sel_hi:[1,0]
    v_pk_mul_f32 v[82:83], v[82:83], v[20:21] op_sel_hi:[1,0]
    v_pk_mul_f32 v[84:85], v[84:85], v[20:21] op_sel_hi:[1,0]
    v_pk_mul_f32 v[86:87], v[86:87], v[20:21] op_sel_hi:[1,0]
    v_pk_mul_f32 v[88:89], v[88:89], v[20:21] op_sel_hi:[1,0]
    v_pk_mul_f32 v[90:91], v[90:91], v[20:21] op_sel_hi:[1,0]
    v_pk_mul_f32 v[92:93], v[92:93], v[20:21] op_sel_hi:[1,0]
    v_pk_mul_f32 v[94:95], v[94:95], v[20:21] op_sel_hi:[1,0]
    v_cvt_pk_bf16_f32 v112, v80, v81
    v_cvt_pk_bf16_f32 v113, v82, v83
    v_cvt_pk_bf16_f32 v114, v84, v85
    v_cvt_pk_bf16_f32 v115, v86, v87
    v_cvt_pk_bf16_f32 v116, v88, v89
    v_cvt_pk_bf16_f32 v117, v90, v91
    v_cvt_pk_bf16_f32 v118, v92, v93
    s_add_u32 m0, s63, 0x1c000
    s_mul_i32 s14, s15, 114688
    s_add_u32 s14, s14, s58
    s_add_u32 s15, s15, 1
    s_cmp_eq_u32 s15, 7
    s_cselect_b32 s15, 0, s15
    s_add_u32 s65, s14, 0xe000
    buffer_load_dwordx4 v12, s[40:43], s65 offen lds
    v_cvt_pk_bf16_f32 v119, v94, v95
    v_and_b32 v118, v28, v118
    v_and_b32 v119, v28, v119
    s_waitcnt lgkmcnt(4)
    v_mfma_f32_32x32x16_bf16 v[48:63], a[0:3], v[112:115], v[48:63]
    v_mfma_f32_32x32x16_bf16 v[64:79], a[4:7], v[112:115], v[64:79]
    s_waitcnt lgkmcnt(0)
    v_mfma_f32_32x32x16_bf16 v[48:63], a[8:11], v[116:119], v[48:63]
    v_mfma_f32_32x32x16_bf16 v[64:79], a[12:15], v[116:119], v[64:79]
    ds_read_b64_tr_b16 a[0:1], v10 offset:24576
    ds_read_b64_tr_b16 a[2:3], v10 offset:25600
    ds_read_b64_tr_b16 a[4:5], v11 offset:24576
    ds_read_b64_tr_b16 a[6:7], v11 offset:25600
    ds_read_b64_tr_b16 a[8:9], v10 offset:28672
    ds_read_b64_tr_b16 a[10:11], v10 offset:29696
    ds_read_b64_tr_b16 a[12:13], v11 offset:28672
    ds_read_b64_tr_b16 a[14:15], v11 offset:29696
    s_waitcnt vmcnt(11)
    v_mfma_f32_32x32x16_bf16 v[80:95], v[208:211], v[144:147], 0
    v_mfma_f32_32x32x16_bf16 v[80:95], v[212:215], v[148:151], v[80:95]
    v_mov_b32 v20, v108
    s_nop 1
    v_permlane32_swap_b32 v108, v20
    v_add_f32 v20, 0x358637bd, v20
    v_rcp_f32 v20, v20
    s_nop 0
    v_pk_mul_f32 v[96:97], v[96:97], v[20:21] op_sel_hi:[1,0]
    v_pk_mul_f32 v[98:99], v[98:99], v[20:21] op_sel_hi:[1,0]
    v_pk_mul_f32 v[100:101], v[100:101], v[20:21] op_sel_hi:[1,0]
    v_pk_mul_f32 v[102:103], v[102:103], v[20:21] op_sel_hi:[1,0]
    v_pk_mul_f32 v[104:105], v[104:105], v[20:21] op_sel_hi:[1,0]
    v_pk_mul_f32 v[106:107], v[106:107], v[20:21] op_sel_hi:[1,0]
    v_pk_mul_f32 v[108:109], v[108:109], v[20:21] op_sel_hi:[1,0]
    v_pk_mul_f32 v[110:111], v[110:111], v[20:21] op_sel_hi:[1,0]
    v_cvt_pk_bf16_f32 v120, v96, v97
    v_cvt_pk_bf16_f32 v121, v98, v99
    s_add_u32 m0, s63, 0x1d000
    s_add_u32 s65, s14, 0x11800
    buffer_load_dwordx4 v12, s[40:43], s65 offen lds
    v_cvt_pk_bf16_f32 v122, v100, v101
    v_cvt_pk_bf16_f32 v123, v102, v103
    v_cvt_pk_bf16_f32 v124, v104, v105
    v_cvt_pk_bf16_f32 v125, v106, v107
    v_cvt_pk_bf16_f32 v126, v108, v109
    v_cvt_pk_bf16_f32 v127, v110, v111
    v_and_b32 v126, v28, v126
    v_and_b32 v127, v28, v127
    s_waitcnt lgkmcnt(4)
    v_mfma_f32_32x32x16_bf16 v[48:63], a[0:3], v[120:123], v[48:63]
    v_mfma_f32_32x32x16_bf16 v[64:79], a[4:7], v[120:123], v[64:79]
    s_waitcnt lgkmcnt(0)
    v_mfma_f32_32x32x16_bf16 v[48:63], a[8:11], v[124:127], v[48:63]
    v_mfma_f32_32x32x16_bf16 v[64:79], a[12:15], v[124:127], v[64:79]
    ds_read_b64_tr_b16 a[0:1], v6 offset:0
    ds_read_b64_tr_b16 a[2:3], v6 offset:1024
    ds_read_b64_tr_b16 a[4:5], v7 offset:0
    ds_read_b64_tr_b16 a[6:7], v7 offset:1024
    ds_read_b64_tr_b16 a[8:9], v6 offset:4096
    ds_read_b64_tr_b16 a[10:11], v6 offset:5120
    ds_read_b64_tr_b16 a[12:13], v7 offset:4096
    ds_read_b64_tr_b16 a[14:15], v7 offset:5120
    s_waitcnt vmcnt(10)
    v_mfma_f32_32x32x16_bf16 v[96:111], v[216:219], v[152:155], 0
    v_mfma_f32_32x32x16_bf16 v[96:111], v[220:223], v[156:159], v[96:111]
    v_mov_b32 v20, v92
    s_nop 1
    v_permlane32_swap_b32 v92, v20
    v_add_f32 v20, 0x358637bd, v20
    v_rcp_f32 v20, v20
    s_nop 0
    v_pk_mul_f32 v[80:81], v[80:81], v[20:21] op_sel_hi:[1,0]
    v_pk_mul_f32 v[82:83], v[82:83], v[20:21] op_sel_hi:[1,0]
    v_pk_mul_f32 v[84:85], v[84:85], v[20:21] op_sel_hi:[1,0]
    v_pk_mul_f32 v[86:87], v[86:87], v[20:21] op_sel_hi:[1,0]
    v_pk_mul_f32 v[88:89], v[88:89], v[20:21] op_sel_hi:[1,0]
    s_add_u32 m0, s63, 0x1e000
    s_add_u32 s65, s14, 0x15000
    buffer_load_dwordx4 v12, s[40:43], s65 offen lds
    v_pk_mul_f32 v[90:91], v[90:91], v[20:21] op_sel_hi:[1,0]
    v_pk_mul_f32 v[92:93], v[92:93], v[20:21] op_sel_hi:[1,0]
    v_pk_mul_f32 v[94:95], v[94:95], v[20:21] op_sel_hi:[1,0]
    v_cvt_pk_bf16_f32 v112, v80, v81
    v_cvt_pk_bf16_f32 v113, v82, v83
    v_cvt_pk_bf16_f32 v114, v84, v85
    v_cvt_pk_bf16_f32 v115, v86, v87
    v_cvt_pk_bf16_f32 v116, v88, v89
    v_cvt_pk_bf16_f32 v117, v90, v91
    v_cvt_pk_bf16_f32 v118, v92, v93
    v_cvt_pk_bf16_f32 v119, v94, v95
    v_and_b32 v118, v28, v118
    v_and_b32 v119, v28, v119
    s_waitcnt lgkmcnt(4)
    v_mfma_f32_32x32x16_bf16 v[48:63], a[0:3], v[112:115], v[48:63]
    v_mfma_f32_32x32x16_bf16 v[64:79], a[4:7], v[112:115], v[64:79]
    s_waitcnt lgkmcnt(0)
    v_mfma_f32_32x32x16_bf16 v[48:63], a[8:11], v[116:119], v[48:63]
    v_mfma_f32_32x32x16_bf16 v[64:79], a[12:15], v[116:119], v[64:79]
    ds_read_b64_tr_b16 a[0:1], v6 offset:8192
    ds_read_b64_tr_b16 a[2:3], v6 offset:9216
    ds_read_b64_tr_b16 a[4:5], v7 offset:8192
    ds_read_b64_tr_b16 a[6:7], v7 offset:9216
    ds_read_b64_tr_b16 a[8:9], v6 offset:12288
    ds_read_b64_tr_b16 a[10:11], v6 offset:13312
    ds_read_b64_tr_b16 a[12:13], v7 offset:12288
    ds_read_b64_tr_b16 a[14:15], v7 offset:13312
    v_mov_b32 v20, v108
    s_nop 1
    v_permlane32_swap_b32 v108, v20
    v_add_f32 v20, 0x358637bd, v20
    v_rcp_f32 v20, v20
    s_nop 0
    v_pk_mul_f32 v[96:97], v[96:97], v[20:21] op_sel_hi:[1,0]
    v_pk_mul_f32 v[98:99], v[98:99], v[20:21] op_sel_hi:[1,0]
    s_add_u32 m0, s63, 0x1f000
    s_add_u32 s65, s14, 0x18800
    buffer_load_dwordx4 v12, s[40:43], s65 offen lds
    v_pk_mul_f32 v[100:101], v[100:101], v[20:21] op_sel_hi:[1,0]
    v_pk_mul_f32 v[102:103], v[102:103], v[20:21] op_sel_hi:[1,0]
    v_pk_mul_f32 v[104:105], v[104:105], v[20:21] op_sel_hi:[1,0]
    v_pk_mul_f32 v[106:107], v[106:107], v[20:21] op_sel_hi:[1,0]
    v_pk_mul_f32 v[108:109], v[108:109], v[20:21] op_sel_hi:[1,0]
    v_pk_mul_f32 v[110:111], v[110:111], v[20:21] op_sel_hi:[1,0]
    v_cvt_pk_bf16_f32 v120, v96, v97
    v_cvt_pk_bf16_f32 v121, v98, v99
    v_cvt_pk_bf16_f32 v122, v100, v101
    v_cvt_pk_bf16_f32 v123, v102, v103
    v_cvt_pk_bf16_f32 v124, v104, v105
    v_cvt_pk_bf16_f32 v125, v106, v107
    v_cvt_pk_bf16_f32 v126, v108, v109
    v_cvt_pk_bf16_f32 v127, v110, v111
    v_and_b32 v126, v28, v126
    v_and_b32 v127, v28, v127
    s_waitcnt lgkmcnt(4)
    v_mfma_f32_32x32x16_bf16 v[48:63], a[0:3], v[120:123], v[48:63]
    v_mfma_f32_32x32x16_bf16 v[64:79], a[4:7], v[120:123], v[64:79]
    s_waitcnt lgkmcnt(0)
    v_mfma_f32_32x32x16_bf16 v[48:63], a[8:11], v[124:127], v[48:63]
    v_mfma_f32_32x32x16_bf16 v[64:79], a[12:15], v[124:127], v[64:79]
    s_barrier
    s_add_u32 m0, s63, 0x20000
    s_mul_i32 s14, s15, 114688
    s_add_u32 s14, s14, s58
    s_add_u32 s15, s15, 1
    s_cmp_eq_u32 s15, 7
    s_cselect_b32 s15, 0, s15
    s_add_u32 s65, s14, 0xe000
    buffer_load_dwordx4 v12, s[40:43], s65 offen lds
    s_add_u32 m0, s63, 0x21000
    s_add_u32 s65, s14, 0x11800
    buffer_load_dwordx4 v12, s[40:43], s65 offen lds
    s_add_u32 m0, s63, 0x22000
    s_add_u32 s65, s14, 0x15000
    buffer_load_dwordx4 v12, s[40:43], s65 offen lds
    s_add_u32 m0, s63, 0x23000
    s_add_u32 s65, s14, 0x18800
    buffer_load_dwordx4 v12, s[40:43], s65 offen lds
    s_barrier
    s_waitcnt vmcnt(12)
    s_barrier
    s_waitcnt vmcnt(8)
    s_barrier
    s_waitcnt vmcnt(4)
    s_barrier
    s_waitcnt vmcnt(0)
    s_barrier
    s_lshl_b32 s64, s52, 12
    s_add_u32 s64, s64, 81920
    v_add_u32 v20, s64, v1
    s_xor_b32 s64, s52, 2
    s_lshl_b32 s64, s64, 12
    s_add_u32 s64, s64, 81920
    v_add_u32 v21, s64, v1
    s_lshl_b32 s64, s52, 12
    s_add_u32 s64, s64, 98304
    v_add_u32 v22, s64, v1
    ds_write_b128 v20, v[64:67] offset:0
    ds_write_b128 v20, v[68:71] offset:1024
    ds_write_b128 v20, v[72:75] offset:2048
    ds_write_b128 v20, v[76:79] offset:3072
    s_waitcnt lgkmcnt(0)
    s_barrier
    ds_read_b128 v[64:67], v21 offset:0
    ds_read_b128 v[68:71], v21 offset:1024
    ds_read_b128 v[72:75], v21 offset:2048
    ds_read_b128 v[76:79], v21 offset:3072
    s_waitcnt lgkmcnt(3)
    v_add_f32 v48, v48, v64
    v_add_f32 v49, v49, v65
    v_add_f32 v50, v50, v66
    v_add_f32 v51, v51, v67
    ds_write_b128 v22, v[48:51] offset:0
    s_waitcnt lgkmcnt(3)
    v_add_f32 v52, v52, v68
    v_add_f32 v53, v53, v69
    v_add_f32 v54, v54, v70
    v_add_f32 v55, v55, v71
    ds_write_b128 v22, v[52:55] offset:1024
    s_waitcnt lgkmcnt(3)
    v_add_f32 v56, v56, v72
    v_add_f32 v57, v57, v73
    v_add_f32 v58, v58, v74
    v_add_f32 v59, v59, v75
    ds_write_b128 v22, v[56:59] offset:2048
    s_waitcnt lgkmcnt(3)
    v_add_f32 v60, v60, v76
    v_add_f32 v61, v61, v77
    v_add_f32 v62, v62, v78
    v_add_f32 v63, v63, v79
    ds_write_b128 v22, v[60:63] offset:3072
    s_waitcnt lgkmcnt(0)
    s_barrier
    s_endpgm
L_Hattn:
    s_nop 7
    s_lshl_b32 s64, s56, 4
    s_add_u32 s64, s64, s53
    s_lshl_b32 s64, s64, 2
    s_add_u32 s64, s64, s52
    s_lshl_b32 s64, s64, 2
    s_add_u32 s64, s64, 0xa12000
    s_waitcnt vmcnt(0)
    buffer_store_dword v30, off, s[36:39], s64 offset:0 sc1
    s_barrier
    s_barrier
    s_barrier
    s_barrier
    s_barrier
    s_barrier
    s_endpgm
LS_noncec:
    s_nop 4
    s_mov_b32 s68, 0x40000
LS_noncec_l:
    global_load_dword v30, v31, s[20:21] sc1
    s_waitcnt vmcnt(0)
    v_cmp_eq_u32 vcc, 0, v30
    s_cbranch_vccz LB_noncec
    s_sleep 1
    s_sub_u32 s68, s68, 1
    s_cbranch_scc0 LS_noncec_l
    s_branch LB_noncec
LS_h1:
    s_nop 4
    s_mov_b32 s68, 0x40000
LS_h1_l:
    buffer_load_dword v2, v31, s[36:39], s69 offen offset:32 sc1
    s_waitcnt vmcnt(0)
    v_cmp_ne_u32 vcc, s67, v2
    s_cbranch_vccz LB_h1
    s_sleep 1
    s_sub_u32 s68, s68, 1
    s_cbranch_scc0 LS_h1_l
    s_branch LB_h1
LS_h0:
    s_nop 4
    s_mov_b32 s68, 0x40000
LS_h0_l:
    buffer_load_dword v2, v31, s[36:39], s69 offen offset:0 sc1
    s_waitcnt vmcnt(0)
    v_cmp_ne_u32 vcc, s67, v2
    s_cbranch_vccz LB_h0
    s_sleep 1
    s_sub_u32 s68, s68, 1
    s_cbranch_scc0 LS_h0_l
    s_branch LB_h0
LS_nonceh:
    s_nop 4
    s_mov_b32 s68, 0x40000
LS_nonceh_l:
    global_load_dword v30, v31, s[20:21] sc1
    s_waitcnt vmcnt(0)
    v_cmp_eq_u32 vcc, 0, v30
    s_cbranch_vccz LB_nonceh
    s_sleep 1
    s_sub_u32 s68, s68, 1
    s_cbranch_scc0 LS_nonceh_l
    s_branch LB_nonceh
LS_fph:
    s_nop 4
    s_mov_b32 s68, 0x40000
LS_fph_l:
    buffer_load_dword v2, v31, s[36:39], s7 offen offset:0 sc1
    s_waitcnt vmcnt(0)
    v_cmp_ne_u32 vcc, s67, v2
    s_cbranch_vccz LB_fph
    s_sleep 1
    s_sub_u32 s68, s68, 1
    s_cbranch_scc0 LS_fph_l
    s_branch LB_fph
LS_fr0:
    s_nop 4
    s_mov_b32 s68, 0x40000
LS_fr0_l:
    buffer_load_dwordx4 v[2:5], v31, s[36:39], s7 offen offset:0 sc1
    s_waitcnt vmcnt(0)
    v_cmp_ne_u32 vcc, s67, v2
    v_cmp_ne_u32 s[12:13], s67, v3
    s_nop 0
    s_or_b64 vcc, vcc, s[12:13]
    v_cmp_ne_u32 s[12:13], s67, v4
    s_nop 0
    s_or_b64 vcc, vcc, s[12:13]
    v_cmp_ne_u32 s[12:13], s67, v5
    s_nop 0
    s_or_b64 vcc, vcc, s[12:13]
    s_cbranch_vccz LB_fr0
    s_sleep 1
    s_sub_u32 s68, s68, 1
    s_cbranch_scc0 LS_fr0_l
    s_branch LB_fr0
LS_fr1:
    s_nop 4
    s_mov_b32 s68, 0x40000
LS_fr1_l:
    buffer_load_dwordx4 v[16:19], v31, s[36:39], s7 offen offset:1024 sc1
    s_waitcnt vmcnt(0)
    v_cmp_ne_u32 vcc, s67, v16
    v_cmp_ne_u32 s[12:13], s67, v17
    s_nop 0
    s_or_b64 vcc, vcc, s[12:13]
    v_cmp_ne_u32 s[12:13], s67, v18
    s_nop 0
    s_or_b64 vcc, vcc, s[12:13]
    v_cmp_ne_u32 s[12:13], s67, v19
    s_nop 0
    s_or_b64 vcc, vcc, s[12:13]
    s_cbranch_vccz LB_fr1
    s_sleep 1
    s_sub_u32 s68, s68, 1
    s_cbranch_scc0 LS_fr1_l
    s_branch LB_fr1
LS_pq0:
    s_nop 4
    s_mov_b32 s68, 0x40000
LS_pq0_l:
    buffer_load_dword v14, v15, s[36:39], s69 offen offset:0 sc1
    s_waitcnt vmcnt(0)
    v_cmp_ne_u32 vcc, s67, v14
    s_cbranch_vccz LB_pq0
    s_sleep 1
    s_sub_u32 s68, s68, 1
    s_cbranch_scc0 LS_pq0_l
    s_branch LB_pq0
LS_pq1:
    s_nop 4
    s_mov_b32 s68, 0x40000
LS_pq1_l:
    buffer_load_dword v14, v15, s[36:39], s69 offen offset:32 sc1
    s_waitcnt vmcnt(0)
    v_cmp_ne_u32 vcc, s67, v14
    s_cbranch_vccz LB_pq1
    s_sleep 1
    s_sub_u32 s68, s68, 1
    s_cbranch_scc0 LS_pq1_l
    s_branch LB_pq1
.section .rodata,"a"
.p2align 6
.amdhsa_kernel recurrent_scan__linear_attn_block__swiglu_ffn__prompt_kernel
  .amdhsa_next_free_vgpr 256
  .amdhsa_next_free_sgpr 102
  .amdhsa_accum_offset 224
  .amdhsa_group_segment_fixed_size 0
  .amdhsa_kernarg_size 80
  .amdhsa_user_sgpr_count 2
  .amdhsa_user_sgpr_kernarg_segment_ptr 1
  .amdhsa_system_sgpr_workgroup_id_x 1
  .amdhsa_float_denorm_mode_32 3
.end_amdhsa_kernel
```
